```python
import torch

def _softmax(x, axis=-1):
    return torch.softmax(x, dim=axis)
def _gelu(x):
    return torch.nn.functional.gelu(x, approximate="tanh")
def _silu(x):
    return torch.nn.functional.silu(x)
def _sigmoid(x):
    return torch.sigmoid(x)
def _layernorm(x, axis=-1, eps=1e-5):
    m = x.mean(dim=axis, keepdim=True)
    v = x.var(dim=axis, keepdim=True, unbiased=False)
    return (x - m) / torch.sqrt(v + eps)
def _scatter_add(tgt, idx, src, axis=0):
    return tgt.clone().index_add_(axis, idx, src)
def _segment_sum(src, seg, n):
    out = torch.zeros((n,) + src.shape[1:], dtype=src.dtype)
    return out.index_add_(0, seg, src)
def _pad(x, pw):
    flat = tuple(v for pair in reversed(pw) for v in pair)
    return torch.nn.functional.pad(x, flat)

kernel_name = 'standalone__gqa_block_cached__sampling'

def setup_inputs():

    _w = (lambda a: (lambda t: t.to(torch.bfloat16) if t.is_floating_point() else t)(torch.as_tensor(a)))
    B, Sq, D = 32, 32, 1024
    Hq, Hkv, Sk, Dh = 32, 4, 2048, 128
    assert Hq % Hkv == 0, (Hq, Hkv)
    return {
        "x": _w((lambda *s: torch.randn(*s, dtype=torch.bfloat16) * 0.8)(B, Sq, D)),
        "k_cache": _w((lambda *s: torch.randn(*s, dtype=torch.bfloat16) * 0.8)(B, Hkv, Sk, Dh)),
        "v_cache": _w((lambda *s: torch.randn(*s, dtype=torch.bfloat16) * 0.05)(B, Hkv, Sk, Dh)),
        "wq": _w((lambda *s: torch.randn(*s, dtype=torch.bfloat16) * 0.8)(D, Hq * Dh) * (D ** -0.5)),
        "wo": _w((lambda *s: torch.randn(*s, dtype=torch.bfloat16) * 0.05)(Hq * Dh, D) * ((Hq * Dh) ** -0.5)),
    }

def reference(x, k_cache, v_cache, wq, wo):
    B, Sq, D = x.shape
    Hq, Dh = 32, 128
    Hkv = k_cache.shape[1]
    rep = Hq // Hkv
    q = (lambda x, *d: x.permute(*d))((x @ wq).reshape(B, Sq, Hq, Dh), 0, 2, 1, 3)
    k = (lambda x, n, axis: torch.repeat_interleave(x, n, dim=axis))(k_cache, rep, axis=1)
    v = (lambda x, n, axis: torch.repeat_interleave(x, n, dim=axis))(v_cache, rep, axis=1)
    scores = torch.einsum("bhqd,bhkd->bhqk", q, k) * (Dh ** -0.5)
    p = _softmax(scores, axis=-1)
    o = torch.einsum("bhqk,bhkd->bhqd", p, v)
    return (lambda x, *d: x.permute(*d))(o, 0, 2, 1, 3).reshape(B, Sq, Hq * Dh) @ wo
```

```asm
; @launch kernel=gqa_qproj_kernel grid=(256,1,1) block=(512,1,1) lds=131072
; @launch kernel=gqa_attn_kernel grid=(256,1,1) block=(512,1,1) lds=131072
; @launch kernel=gqa_oproj_kernel grid=(256,1,1) block=(512,1,1) lds=65536
.amdgcn_target "amdgcn-amd-amdhsa--gfx950"
.text
.globl gqa_qproj_kernel
.p2align 8
.type gqa_qproj_kernel,@function
gqa_qproj_kernel:
    s_cmp_ge_u32 s2, 256
    s_cbranch_scc1 L_gqa_qproj_kernel_end
    s_load_dwordx2 s[4:5], s[0:1], 0
    s_load_dwordx2 s[6:7], s[0:1], 24
    s_load_dwordx2 s[8:9], s[0:1], 56
    v_lshrrev_b32 v1, 6, v0
    v_and_b32 v0, 63, v0
    s_nop 1
    v_readfirstlane_b32 s24, v1
    s_nop 3
    s_lshl_b32 s25, s24, 10
    s_and_b32 s31, s2, 7
    s_lshl_b32 s31, s31, 2
    s_lshr_b32 s27, s2, 3
    s_and_b32 s27, s27, 3
    s_add_u32 s27, s27, s31
    s_lshr_b32 s26, s2, 5
    s_and_b32 s35, s24, 1
    s_lshr_b32 s36, s24, 1
    s_mov_b32 s34, 0
    s_waitcnt lgkmcnt(0)
    s_mov_b32 s12, s4
    s_mov_b32 s13, s5
    s_mov_b32 s14, 2097152
    s_mov_b32 s15, 0x00020000
    s_mov_b32 s16, s6
    s_mov_b32 s17, s7
    s_mov_b32 s18, 8388608
    s_mov_b32 s19, 0x00020000
    s_mov_b32 s20, s8
    s_mov_b32 s21, s9
    s_mov_b32 s22, 8388608
    s_mov_b32 s23, 0x00020000
    v_lshrrev_b32 v1, 3, v0
    v_and_b32 v2, 7, v0
    v_lshrrev_b32 v3, 4, v0
    s_lshl_b32 s31, s24, 2
    v_add_u32 v3, s31, v3
    v_and_b32 v3, 7, v3
    v_xor_b32 v2, v2, v3
    s_lshl_b32 s31, s24, 3
    s_mul_i32 s32, s26, 128
    s_add_u32 s31, s31, s32
    v_add_u32 v1, s31, v1
    v_lshlrev_b32 v1, 11, v1
    v_lshl_add_u32 v7, v2, 4, v1
    s_mov_b32 s31, 131072
    v_add_u32 v8, s31, v7
    v_lshrrev_b32 v1, 4, v0
    v_and_b32 v2, 15, v0
    v_lshlrev_b32 v3, 2, v1
    v_xor_b32 v2, v2, v3
    s_lshl_b32 s31, s24, 2
    v_add_u32 v1, s31, v1
    v_lshlrev_b32 v1, 13, v1
    v_lshl_add_u32 v1, v2, 4, v1
    s_mul_i32 s31, s27, 256
    v_add_u32 v9, s31, v1
    s_mov_b32 s31, 262144
    v_add_u32 v10, s31, v9
    v_and_b32 v1, 31, v0
    v_lshrrev_b32 v2, 1, v1
    v_and_b32 v2, 7, v2
    v_lshrrev_b32 v3, 5, v0
    v_xor_b32 v2, v2, v3
    s_mul_i32 s31, s35, 64
    v_add_u32 v1, s31, v1
    v_lshlrev_b32 v1, 7, v1
    v_lshl_add_u32 v1, v2, 4, v1
    v_mov_b32 v11, v1
    v_xor_b32 v12, 32, v1
    v_xor_b32 v13, 64, v1
    v_xor_b32 v14, 96, v1
    v_and_b32 v1, 15, v0
    v_lshrrev_b32 v2, 2, v1
    v_and_b32 v1, 3, v1
    v_lshrrev_b32 v3, 5, v0
    v_lshl_add_u32 v3, v3, 3, v2
    v_lshlrev_b32 v3, 8, v3
    v_lshl_add_u32 v3, v1, 3, v3
    v_lshrrev_b32 v1, 4, v0
    v_and_b32 v1, 1, v1
    v_lshl_add_u32 v3, v1, 5, v3
    v_xor_b32 v2, s36, v2
    v_lshl_add_u32 v3, v2, 6, v3
    s_lshl_b32 s31, s34, 11
    s_add_u32 s31, s31, 65536
    v_add_u32 v19, s31, v3
    v_add_u32 v15, 49152, v11
    v_add_u32 v16, 49152, v12
    v_add_u32 v17, 49152, v13
    v_add_u32 v18, 49152, v14
    v_add_u32 v20, 49152, v19
    v_and_b32 v1, 31, v0
    s_mul_i32 s31, s26, 128
    s_mul_i32 s32, s35, 64
    s_add_u32 s31, s31, s32
    v_add_u32 v1, s31, v1
    v_lshlrev_b32 v1, 13, v1
    v_lshrrev_b32 v2, 5, v0
    v_lshl_add_u32 v1, v2, 4, v1
    s_mul_i32 s31, s27, 256
    s_lshl_b32 s32, s36, 6
    s_add_u32 s31, s31, s32
    v_add_u32 v21, s31, v1
    s_mov_b32 s31, 262144
    v_add_u32 v22, s31, v21
    v_mov_b32 v24, 0
    v_mov_b32 v25, 0
    v_mov_b32 v26, 0
    v_mov_b32 v27, 0
    v_mov_b32 v28, 0
    v_mov_b32 v29, 0
    v_mov_b32 v30, 0
    v_mov_b32 v31, 0
    v_mov_b32 v32, 0
    v_mov_b32 v33, 0
    v_mov_b32 v34, 0
    v_mov_b32 v35, 0
    v_mov_b32 v36, 0
    v_mov_b32 v37, 0
    v_mov_b32 v38, 0
    v_mov_b32 v39, 0
    v_mov_b32 v40, 0
    v_mov_b32 v41, 0
    v_mov_b32 v42, 0
    v_mov_b32 v43, 0
    v_mov_b32 v44, 0
    v_mov_b32 v45, 0
    v_mov_b32 v46, 0
    v_mov_b32 v47, 0
    v_mov_b32 v48, 0
    v_mov_b32 v49, 0
    v_mov_b32 v50, 0
    v_mov_b32 v51, 0
    v_mov_b32 v52, 0
    v_mov_b32 v53, 0
    v_mov_b32 v54, 0
    v_mov_b32 v55, 0
    s_mov_b32 s28, 0
    s_mov_b32 s29, 0
    s_add_u32 m0, s25, 0
    s_nop 0
    buffer_load_dwordx4 v7, s[12:15], s28 offen lds
    s_add_u32 m0, s25, 8192
    s_nop 0
    buffer_load_dwordx4 v8, s[12:15], s28 offen lds
    s_add_u32 m0, s25, 65536
    s_nop 0
    buffer_load_dwordx4 v9, s[16:19], s29 offen lds
    s_add_u32 m0, s25, 73728
    s_nop 0
    buffer_load_dwordx4 v10, s[16:19], s29 offen lds
    s_add_u32 s28, s28, 128
    s_add_u32 s29, s29, 524288
    s_add_u32 m0, s25, 16384
    s_nop 0
    buffer_load_dwordx4 v7, s[12:15], s28 offen lds
    s_add_u32 m0, s25, 24576
    s_nop 0
    buffer_load_dwordx4 v8, s[12:15], s28 offen lds
    s_add_u32 m0, s25, 81920
    s_nop 0
    buffer_load_dwordx4 v9, s[16:19], s29 offen lds
    s_add_u32 m0, s25, 90112
    s_nop 0
    buffer_load_dwordx4 v10, s[16:19], s29 offen lds
    s_add_u32 s28, s28, 128
    s_add_u32 s29, s29, 524288
    s_add_u32 m0, s25, 32768
    s_nop 0
    buffer_load_dwordx4 v7, s[12:15], s28 offen lds
    s_add_u32 m0, s25, 40960
    s_nop 0
    buffer_load_dwordx4 v8, s[12:15], s28 offen lds
    s_add_u32 m0, s25, 98304
    s_nop 0
    buffer_load_dwordx4 v9, s[16:19], s29 offen lds
    s_add_u32 m0, s25, 106496
    s_nop 0
    buffer_load_dwordx4 v10, s[16:19], s29 offen lds
    s_add_u32 s28, s28, 128
    s_add_u32 s29, s29, 524288
    s_mov_b32 s30, 3
L_gqa_qproj_kernel_loop:
    s_waitcnt vmcnt(8) lgkmcnt(0)
    s_barrier
    s_add_u32 m0, s25, 49152
    s_nop 0
    buffer_load_dwordx4 v7, s[12:15], s28 offen lds
    s_add_u32 m0, s25, 57344
    s_nop 0
    buffer_load_dwordx4 v8, s[12:15], s28 offen lds
    s_add_u32 m0, s25, 114688
    s_nop 0
    buffer_load_dwordx4 v9, s[16:19], s29 offen lds
    s_add_u32 m0, s25, 122880
    s_nop 0
    buffer_load_dwordx4 v10, s[16:19], s29 offen lds
    s_add_u32 s28, s28, 128
    s_add_u32 s29, s29, 524288
    ds_read_b64_tr_b16 v[88:89], v19 offset:0
    ds_read_b64_tr_b16 v[90:91], v19 offset:1024
    ds_read_b128 v[56:59], v11 offset:0
    ds_read_b128 v[60:63], v11 offset:4096
    ds_read_b64_tr_b16 v[92:93], v19 offset:4096
    ds_read_b64_tr_b16 v[94:95], v19 offset:5120
    ds_read_b128 v[64:67], v12 offset:0
    ds_read_b128 v[68:71], v12 offset:4096
    ds_read_b64_tr_b16 v[96:97], v19 offset:8192
    ds_read_b64_tr_b16 v[98:99], v19 offset:9216
    ds_read_b128 v[72:75], v13 offset:0
    ds_read_b128 v[76:79], v13 offset:4096
    s_waitcnt lgkmcnt(8)
    v_mfma_f32_32x32x16_bf16 v[24:39], v[88:91], v[56:59], v[24:39]
    v_mfma_f32_32x32x16_bf16 v[40:55], v[88:91], v[60:63], v[40:55]
    ds_read_b64_tr_b16 v[100:101], v19 offset:12288
    ds_read_b64_tr_b16 v[102:103], v19 offset:13312
    ds_read_b128 v[80:83], v14 offset:0
    ds_read_b128 v[84:87], v14 offset:4096
    s_waitcnt lgkmcnt(8)
    v_mfma_f32_32x32x16_bf16 v[24:39], v[92:95], v[64:67], v[24:39]
    v_mfma_f32_32x32x16_bf16 v[40:55], v[92:95], v[68:71], v[40:55]
    s_waitcnt lgkmcnt(4)
    v_mfma_f32_32x32x16_bf16 v[24:39], v[96:99], v[72:75], v[24:39]
    v_mfma_f32_32x32x16_bf16 v[40:55], v[96:99], v[76:79], v[40:55]
    s_waitcnt lgkmcnt(0)
    v_mfma_f32_32x32x16_bf16 v[24:39], v[100:103], v[80:83], v[24:39]
    v_mfma_f32_32x32x16_bf16 v[40:55], v[100:103], v[84:87], v[40:55]
    s_waitcnt vmcnt(8) lgkmcnt(0)
    s_barrier
    s_add_u32 m0, s25, 0
    s_nop 0
    buffer_load_dwordx4 v7, s[12:15], s28 offen lds
    s_add_u32 m0, s25, 8192
    s_nop 0
    buffer_load_dwordx4 v8, s[12:15], s28 offen lds
    s_add_u32 m0, s25, 65536
    s_nop 0
    buffer_load_dwordx4 v9, s[16:19], s29 offen lds
    s_add_u32 m0, s25, 73728
    s_nop 0
    buffer_load_dwordx4 v10, s[16:19], s29 offen lds
    s_add_u32 s28, s28, 128
    s_add_u32 s29, s29, 524288
    ds_read_b64_tr_b16 v[88:89], v19 offset:16384
    ds_read_b64_tr_b16 v[90:91], v19 offset:17408
    ds_read_b128 v[56:59], v11 offset:16384
    ds_read_b128 v[60:63], v11 offset:20480
    ds_read_b64_tr_b16 v[92:93], v19 offset:20480
    ds_read_b64_tr_b16 v[94:95], v19 offset:21504
    ds_read_b128 v[64:67], v12 offset:16384
    ds_read_b128 v[68:71], v12 offset:20480
    ds_read_b64_tr_b16 v[96:97], v19 offset:24576
    ds_read_b64_tr_b16 v[98:99], v19 offset:25600
    ds_read_b128 v[72:75], v13 offset:16384
    ds_read_b128 v[76:79], v13 offset:20480
    s_waitcnt lgkmcnt(8)
    v_mfma_f32_32x32x16_bf16 v[24:39], v[88:91], v[56:59], v[24:39]
    v_mfma_f32_32x32x16_bf16 v[40:55], v[88:91], v[60:63], v[40:55]
    ds_read_b64_tr_b16 v[100:101], v19 offset:28672
    ds_read_b64_tr_b16 v[102:103], v19 offset:29696
    ds_read_b128 v[80:83], v14 offset:16384
    ds_read_b128 v[84:87], v14 offset:20480
    s_waitcnt lgkmcnt(8)
    v_mfma_f32_32x32x16_bf16 v[24:39], v[92:95], v[64:67], v[24:39]
    v_mfma_f32_32x32x16_bf16 v[40:55], v[92:95], v[68:71], v[40:55]
    s_waitcnt lgkmcnt(4)
    v_mfma_f32_32x32x16_bf16 v[24:39], v[96:99], v[72:75], v[24:39]
    v_mfma_f32_32x32x16_bf16 v[40:55], v[96:99], v[76:79], v[40:55]
    s_waitcnt lgkmcnt(0)
    v_mfma_f32_32x32x16_bf16 v[24:39], v[100:103], v[80:83], v[24:39]
    v_mfma_f32_32x32x16_bf16 v[40:55], v[100:103], v[84:87], v[40:55]
    s_waitcnt vmcnt(8) lgkmcnt(0)
    s_barrier
    s_add_u32 m0, s25, 16384
    s_nop 0
    buffer_load_dwordx4 v7, s[12:15], s28 offen lds
    s_add_u32 m0, s25, 24576
    s_nop 0
    buffer_load_dwordx4 v8, s[12:15], s28 offen lds
    s_add_u32 m0, s25, 81920
    s_nop 0
    buffer_load_dwordx4 v9, s[16:19], s29 offen lds
    s_add_u32 m0, s25, 90112
    s_nop 0
    buffer_load_dwordx4 v10, s[16:19], s29 offen lds
    s_add_u32 s28, s28, 128
    s_add_u32 s29, s29, 524288
    ds_read_b64_tr_b16 v[88:89], v19 offset:32768
    ds_read_b64_tr_b16 v[90:91], v19 offset:33792
    ds_read_b128 v[56:59], v11 offset:32768
    ds_read_b128 v[60:63], v11 offset:36864
    ds_read_b64_tr_b16 v[92:93], v19 offset:36864
    ds_read_b64_tr_b16 v[94:95], v19 offset:37888
    ds_read_b128 v[64:67], v12 offset:32768
    ds_read_b128 v[68:71], v12 offset:36864
    ds_read_b64_tr_b16 v[96:97], v19 offset:40960
    ds_read_b64_tr_b16 v[98:99], v19 offset:41984
    ds_read_b128 v[72:75], v13 offset:32768
    ds_read_b128 v[76:79], v13 offset:36864
    s_waitcnt lgkmcnt(8)
    v_mfma_f32_32x32x16_bf16 v[24:39], v[88:91], v[56:59], v[24:39]
    v_mfma_f32_32x32x16_bf16 v[40:55], v[88:91], v[60:63], v[40:55]
    ds_read_b64_tr_b16 v[100:101], v19 offset:45056
    ds_read_b64_tr_b16 v[102:103], v19 offset:46080
    ds_read_b128 v[80:83], v14 offset:32768
    ds_read_b128 v[84:87], v14 offset:36864
    s_waitcnt lgkmcnt(8)
    v_mfma_f32_32x32x16_bf16 v[24:39], v[92:95], v[64:67], v[24:39]
    v_mfma_f32_32x32x16_bf16 v[40:55], v[92:95], v[68:71], v[40:55]
    s_waitcnt lgkmcnt(4)
    v_mfma_f32_32x32x16_bf16 v[24:39], v[96:99], v[72:75], v[24:39]
    v_mfma_f32_32x32x16_bf16 v[40:55], v[96:99], v[76:79], v[40:55]
    s_waitcnt lgkmcnt(0)
    v_mfma_f32_32x32x16_bf16 v[24:39], v[100:103], v[80:83], v[24:39]
    v_mfma_f32_32x32x16_bf16 v[40:55], v[100:103], v[84:87], v[40:55]
    s_waitcnt vmcnt(8) lgkmcnt(0)
    s_barrier
    s_add_u32 m0, s25, 32768
    s_nop 0
    buffer_load_dwordx4 v7, s[12:15], s28 offen lds
    s_add_u32 m0, s25, 40960
    s_nop 0
    buffer_load_dwordx4 v8, s[12:15], s28 offen lds
    s_add_u32 m0, s25, 98304
    s_nop 0
    buffer_load_dwordx4 v9, s[16:19], s29 offen lds
    s_add_u32 m0, s25, 106496
    s_nop 0
    buffer_load_dwordx4 v10, s[16:19], s29 offen lds
    s_add_u32 s28, s28, 128
    s_add_u32 s29, s29, 524288
    ds_read_b64_tr_b16 v[88:89], v20 offset:0
    ds_read_b64_tr_b16 v[90:91], v20 offset:1024
    ds_read_b128 v[56:59], v15 offset:0
    ds_read_b128 v[60:63], v15 offset:4096
    ds_read_b64_tr_b16 v[92:93], v20 offset:4096
    ds_read_b64_tr_b16 v[94:95], v20 offset:5120
    ds_read_b128 v[64:67], v16 offset:0
    ds_read_b128 v[68:71], v16 offset:4096
    ds_read_b64_tr_b16 v[96:97], v20 offset:8192
    ds_read_b64_tr_b16 v[98:99], v20 offset:9216
    ds_read_b128 v[72:75], v17 offset:0
    ds_read_b128 v[76:79], v17 offset:4096
    s_waitcnt lgkmcnt(8)
    v_mfma_f32_32x32x16_bf16 v[24:39], v[88:91], v[56:59], v[24:39]
    v_mfma_f32_32x32x16_bf16 v[40:55], v[88:91], v[60:63], v[40:55]
    ds_read_b64_tr_b16 v[100:101], v20 offset:12288
    ds_read_b64_tr_b16 v[102:103], v20 offset:13312
    ds_read_b128 v[80:83], v18 offset:0
    ds_read_b128 v[84:87], v18 offset:4096
    s_waitcnt lgkmcnt(8)
    v_mfma_f32_32x32x16_bf16 v[24:39], v[92:95], v[64:67], v[24:39]
    v_mfma_f32_32x32x16_bf16 v[40:55], v[92:95], v[68:71], v[40:55]
    s_waitcnt lgkmcnt(4)
    v_mfma_f32_32x32x16_bf16 v[24:39], v[96:99], v[72:75], v[24:39]
    v_mfma_f32_32x32x16_bf16 v[40:55], v[96:99], v[76:79], v[40:55]
    s_waitcnt lgkmcnt(0)
    v_mfma_f32_32x32x16_bf16 v[24:39], v[100:103], v[80:83], v[24:39]
    v_mfma_f32_32x32x16_bf16 v[40:55], v[100:103], v[84:87], v[40:55]
    s_sub_u32 s30, s30, 1
    s_cmp_lg_u32 s30, 0
    s_cbranch_scc1 L_gqa_qproj_kernel_loop
    s_waitcnt vmcnt(8) lgkmcnt(0)
    s_barrier
    s_add_u32 m0, s25, 49152
    s_nop 0
    buffer_load_dwordx4 v7, s[12:15], s28 offen lds
    s_add_u32 m0, s25, 57344
    s_nop 0
    buffer_load_dwordx4 v8, s[12:15], s28 offen lds
    s_add_u32 m0, s25, 114688
    s_nop 0
    buffer_load_dwordx4 v9, s[16:19], s29 offen lds
    s_add_u32 m0, s25, 122880
    s_nop 0
    buffer_load_dwordx4 v10, s[16:19], s29 offen lds
    s_add_u32 s28, s28, 128
    s_add_u32 s29, s29, 524288
    ds_read_b64_tr_b16 v[88:89], v19 offset:0
    ds_read_b64_tr_b16 v[90:91], v19 offset:1024
    ds_read_b128 v[56:59], v11 offset:0
    ds_read_b128 v[60:63], v11 offset:4096
    ds_read_b64_tr_b16 v[92:93], v19 offset:4096
    ds_read_b64_tr_b16 v[94:95], v19 offset:5120
    ds_read_b128 v[64:67], v12 offset:0
    ds_read_b128 v[68:71], v12 offset:4096
    ds_read_b64_tr_b16 v[96:97], v19 offset:8192
    ds_read_b64_tr_b16 v[98:99], v19 offset:9216
    ds_read_b128 v[72:75], v13 offset:0
    ds_read_b128 v[76:79], v13 offset:4096
    s_waitcnt lgkmcnt(8)
    v_mfma_f32_32x32x16_bf16 v[24:39], v[88:91], v[56:59], v[24:39]
    v_mfma_f32_32x32x16_bf16 v[40:55], v[88:91], v[60:63], v[40:55]
    ds_read_b64_tr_b16 v[100:101], v19 offset:12288
    ds_read_b64_tr_b16 v[102:103], v19 offset:13312
    ds_read_b128 v[80:83], v14 offset:0
    ds_read_b128 v[84:87], v14 offset:4096
    s_waitcnt lgkmcnt(8)
    v_mfma_f32_32x32x16_bf16 v[24:39], v[92:95], v[64:67], v[24:39]
    v_mfma_f32_32x32x16_bf16 v[40:55], v[92:95], v[68:71], v[40:55]
    s_waitcnt lgkmcnt(4)
    v_mfma_f32_32x32x16_bf16 v[24:39], v[96:99], v[72:75], v[24:39]
    v_mfma_f32_32x32x16_bf16 v[40:55], v[96:99], v[76:79], v[40:55]
    s_waitcnt lgkmcnt(0)
    v_mfma_f32_32x32x16_bf16 v[24:39], v[100:103], v[80:83], v[24:39]
    v_mfma_f32_32x32x16_bf16 v[40:55], v[100:103], v[84:87], v[40:55]
    s_waitcnt vmcnt(8) lgkmcnt(0)
    s_barrier
    ds_read_b64_tr_b16 v[88:89], v19 offset:16384
    ds_read_b64_tr_b16 v[90:91], v19 offset:17408
    ds_read_b128 v[56:59], v11 offset:16384
    ds_read_b128 v[60:63], v11 offset:20480
    ds_read_b64_tr_b16 v[92:93], v19 offset:20480
    ds_read_b64_tr_b16 v[94:95], v19 offset:21504
    ds_read_b128 v[64:67], v12 offset:16384
    ds_read_b128 v[68:71], v12 offset:20480
    ds_read_b64_tr_b16 v[96:97], v19 offset:24576
    ds_read_b64_tr_b16 v[98:99], v19 offset:25600
    ds_read_b128 v[72:75], v13 offset:16384
    ds_read_b128 v[76:79], v13 offset:20480
    s_waitcnt lgkmcnt(8)
    v_mfma_f32_32x32x16_bf16 v[24:39], v[88:91], v[56:59], v[24:39]
    v_mfma_f32_32x32x16_bf16 v[40:55], v[88:91], v[60:63], v[40:55]
    ds_read_b64_tr_b16 v[100:101], v19 offset:28672
    ds_read_b64_tr_b16 v[102:103], v19 offset:29696
    ds_read_b128 v[80:83], v14 offset:16384
    ds_read_b128 v[84:87], v14 offset:20480
    s_waitcnt lgkmcnt(8)
    v_mfma_f32_32x32x16_bf16 v[24:39], v[92:95], v[64:67], v[24:39]
    v_mfma_f32_32x32x16_bf16 v[40:55], v[92:95], v[68:71], v[40:55]
    s_waitcnt lgkmcnt(4)
    v_mfma_f32_32x32x16_bf16 v[24:39], v[96:99], v[72:75], v[24:39]
    v_mfma_f32_32x32x16_bf16 v[40:55], v[96:99], v[76:79], v[40:55]
    s_waitcnt lgkmcnt(0)
    v_mfma_f32_32x32x16_bf16 v[24:39], v[100:103], v[80:83], v[24:39]
    v_mfma_f32_32x32x16_bf16 v[40:55], v[100:103], v[84:87], v[40:55]
    s_waitcnt vmcnt(4) lgkmcnt(0)
    s_barrier
    ds_read_b64_tr_b16 v[88:89], v19 offset:32768
    ds_read_b64_tr_b16 v[90:91], v19 offset:33792
    ds_read_b128 v[56:59], v11 offset:32768
    ds_read_b128 v[60:63], v11 offset:36864
    ds_read_b64_tr_b16 v[92:93], v19 offset:36864
    ds_read_b64_tr_b16 v[94:95], v19 offset:37888
    ds_read_b128 v[64:67], v12 offset:32768
    ds_read_b128 v[68:71], v12 offset:36864
    ds_read_b64_tr_b16 v[96:97], v19 offset:40960
    ds_read_b64_tr_b16 v[98:99], v19 offset:41984
    ds_read_b128 v[72:75], v13 offset:32768
    ds_read_b128 v[76:79], v13 offset:36864
    s_waitcnt lgkmcnt(8)
    v_mfma_f32_32x32x16_bf16 v[24:39], v[88:91], v[56:59], v[24:39]
    v_mfma_f32_32x32x16_bf16 v[40:55], v[88:91], v[60:63], v[40:55]
    ds_read_b64_tr_b16 v[100:101], v19 offset:45056
    ds_read_b64_tr_b16 v[102:103], v19 offset:46080
    ds_read_b128 v[80:83], v14 offset:32768
    ds_read_b128 v[84:87], v14 offset:36864
    s_waitcnt lgkmcnt(8)
    v_mfma_f32_32x32x16_bf16 v[24:39], v[92:95], v[64:67], v[24:39]
    v_mfma_f32_32x32x16_bf16 v[40:55], v[92:95], v[68:71], v[40:55]
    s_waitcnt lgkmcnt(4)
    v_mfma_f32_32x32x16_bf16 v[24:39], v[96:99], v[72:75], v[24:39]
    v_mfma_f32_32x32x16_bf16 v[40:55], v[96:99], v[76:79], v[40:55]
    s_waitcnt lgkmcnt(0)
    v_mfma_f32_32x32x16_bf16 v[24:39], v[100:103], v[80:83], v[24:39]
    v_mfma_f32_32x32x16_bf16 v[40:55], v[100:103], v[84:87], v[40:55]
    s_waitcnt vmcnt(0) lgkmcnt(0)
    s_barrier
    ds_read_b64_tr_b16 v[88:89], v20 offset:0
    ds_read_b64_tr_b16 v[90:91], v20 offset:1024
    ds_read_b128 v[56:59], v15 offset:0
    ds_read_b128 v[60:63], v15 offset:4096
    ds_read_b64_tr_b16 v[92:93], v20 offset:4096
    ds_read_b64_tr_b16 v[94:95], v20 offset:5120
    ds_read_b128 v[64:67], v16 offset:0
    ds_read_b128 v[68:71], v16 offset:4096
    ds_read_b64_tr_b16 v[96:97], v20 offset:8192
    ds_read_b64_tr_b16 v[98:99], v20 offset:9216
    ds_read_b128 v[72:75], v17 offset:0
    ds_read_b128 v[76:79], v17 offset:4096
    s_waitcnt lgkmcnt(8)
    v_mfma_f32_32x32x16_bf16 v[24:39], v[88:91], v[56:59], v[24:39]
    v_mfma_f32_32x32x16_bf16 v[40:55], v[88:91], v[60:63], v[40:55]
    ds_read_b64_tr_b16 v[100:101], v20 offset:12288
    ds_read_b64_tr_b16 v[102:103], v20 offset:13312
    ds_read_b128 v[80:83], v18 offset:0
    ds_read_b128 v[84:87], v18 offset:4096
    s_waitcnt lgkmcnt(8)
    v_mfma_f32_32x32x16_bf16 v[24:39], v[92:95], v[64:67], v[24:39]
    v_mfma_f32_32x32x16_bf16 v[40:55], v[92:95], v[68:71], v[40:55]
    s_waitcnt lgkmcnt(4)
    v_mfma_f32_32x32x16_bf16 v[24:39], v[96:99], v[72:75], v[24:39]
    v_mfma_f32_32x32x16_bf16 v[40:55], v[96:99], v[76:79], v[40:55]
    s_waitcnt lgkmcnt(0)
    v_mfma_f32_32x32x16_bf16 v[24:39], v[100:103], v[80:83], v[24:39]
    v_mfma_f32_32x32x16_bf16 v[40:55], v[100:103], v[84:87], v[40:55]
    s_nop 15
    s_barrier
    v_and_b32 v1, 31, v0
    v_and_b32 v2, 15, v1
    v_lshrrev_b32 v3, 5, v0
    s_lshl_b32 s31, s36, 2
    v_add_u32 v3, s31, v3
    v_xor_b32 v3, v3, v2
    s_mul_i32 s31, s35, 64
    v_add_u32 v1, s31, v1
    v_lshlrev_b32 v1, 8, v1
    v_lshl_add_u32 v1, v3, 4, v1
    v_xor_b32 v2, 32, v1
    v_cvt_pk_bf16_f32 v56, v24, v25
    v_cvt_pk_bf16_f32 v57, v26, v27
    v_cvt_pk_bf16_f32 v58, v28, v29
    v_cvt_pk_bf16_f32 v59, v30, v31
    s_nop 1
    v_permlane32_swap_b32 v56, v58
    v_permlane32_swap_b32 v57, v59
    s_nop 1
    ds_write_b128 v1, v[56:59] offset:0
    v_cvt_pk_bf16_f32 v60, v32, v33
    v_cvt_pk_bf16_f32 v61, v34, v35
    v_cvt_pk_bf16_f32 v62, v36, v37
    v_cvt_pk_bf16_f32 v63, v38, v39
    s_nop 1
    v_permlane32_swap_b32 v60, v62
    v_permlane32_swap_b32 v61, v63
    s_nop 1
    ds_write_b128 v2, v[60:63] offset:0
    v_cvt_pk_bf16_f32 v64, v40, v41
    v_cvt_pk_bf16_f32 v65, v42, v43
    v_cvt_pk_bf16_f32 v66, v44, v45
    v_cvt_pk_bf16_f32 v67, v46, v47
    s_nop 1
    v_permlane32_swap_b32 v64, v66
    v_permlane32_swap_b32 v65, v67
    s_nop 1
    ds_write_b128 v1, v[64:67] offset:8192
    v_cvt_pk_bf16_f32 v68, v48, v49
    v_cvt_pk_bf16_f32 v69, v50, v51
    v_cvt_pk_bf16_f32 v70, v52, v53
    v_cvt_pk_bf16_f32 v71, v54, v55
    s_nop 1
    v_permlane32_swap_b32 v68, v70
    v_permlane32_swap_b32 v69, v71
    s_nop 1
    ds_write_b128 v2, v[68:71] offset:8192
    s_waitcnt lgkmcnt(0)
    s_barrier
    v_lshrrev_b32 v1, 4, v0
    v_and_b32 v2, 15, v0
    s_lshl_b32 s31, s24, 4
    v_add_u32 v3, s31, v1
    s_mul_i32 s31, s26, 128
    v_add_u32 v4, s31, v3
    v_lshlrev_b32 v4, 13, v4
    v_lshl_add_u32 v4, v2, 4, v4
    s_mul_i32 s31, s27, 256
    v_add_u32 v4, s31, v4
    v_add_u32 v5, 0, v1
    v_xor_b32 v5, v2, v5
    v_add_u32 v6, 0, v3
    v_lshlrev_b32 v6, 8, v6
    v_lshl_add_u32 v6, v5, 4, v6
    ds_read_b128 v[56:59], v6
    v_add_u32 v5, 4, v1
    v_xor_b32 v5, v2, v5
    v_add_u32 v6, 4, v3
    v_lshlrev_b32 v6, 8, v6
    v_lshl_add_u32 v6, v5, 4, v6
    ds_read_b128 v[60:63], v6
    v_add_u32 v5, 8, v1
    v_xor_b32 v5, v2, v5
    v_add_u32 v6, 8, v3
    v_lshlrev_b32 v6, 8, v6
    v_lshl_add_u32 v6, v5, 4, v6
    ds_read_b128 v[64:67], v6
    v_add_u32 v5, 12, v1
    v_xor_b32 v5, v2, v5
    v_add_u32 v6, 12, v3
    v_lshlrev_b32 v6, 8, v6
    v_lshl_add_u32 v6, v5, 4, v6
    ds_read_b128 v[68:71], v6
    s_waitcnt lgkmcnt(3)
    buffer_store_dwordx4 v[56:59], v4, s[20:23], 0 offen
    s_waitcnt lgkmcnt(2)
    v_add_u32 v4, 32768, v4
    buffer_store_dwordx4 v[60:63], v4, s[20:23], 0 offen
    s_waitcnt lgkmcnt(1)
    v_add_u32 v4, 32768, v4
    buffer_store_dwordx4 v[64:67], v4, s[20:23], 0 offen
    s_waitcnt lgkmcnt(0)
    v_add_u32 v4, 32768, v4
    buffer_store_dwordx4 v[68:71], v4, s[20:23], 0 offen
L_gqa_qproj_kernel_end:
    s_endpgm

.globl gqa_attn_kernel
.p2align 8
.type gqa_attn_kernel,@function
gqa_attn_kernel:
    s_cmp_ge_u32 s2, 256
    s_cbranch_scc1 L_gqa_attn_kernel_end
    s_load_dwordx2 s[4:5], s[0:1], 56
    s_load_dwordx2 s[6:7], s[0:1], 8
    s_load_dwordx2 s[8:9], s[0:1], 16
    s_load_dwordx2 s[10:11], s[0:1], 32
    v_lshrrev_b32 v1, 6, v0
    v_and_b32 v0, 63, v0
    s_nop 1
    v_readfirstlane_b32 s28, v1
    s_nop 3
    s_lshr_b32 s29, s28, 2
    s_and_b32 s30, s28, 3
    s_lshr_b32 s34, s2, 4
    s_lshl_b32 s34, s34, 3
    s_and_b32 s39, s2, 7
    s_add_u32 s34, s34, s39
    s_lshr_b32 s35, s2, 3
    s_and_b32 s35, s35, 1
    s_lshl_b32 s31, s29, 16
    s_lshl_b32 s39, s30, 10
    s_add_u32 s31, s31, s39
    s_lshl_b32 s32, s34, 19
    s_lshl_b32 s39, s29, 18
    s_add_u32 s32, s32, s39
    s_mov_b32 s33, s32
    s_and_b32 s42, s34, 3
    s_lshl_b32 s42, s42, 3
    s_lshl_b32 s39, s35, 2
    s_add_u32 s42, s42, s39
    s_add_u32 s42, s42, s30
    s_mov_b32 s36, 0x3e0293ee
    s_mov_b32 s37, 0x41000000
    s_waitcnt lgkmcnt(0)
    s_mov_b32 s12, s4
    s_mov_b32 s13, s5
    s_mov_b32 s14, 8388608
    s_mov_b32 s15, 0x00020000
    s_mov_b32 s16, s6
    s_mov_b32 s17, s7
    s_mov_b32 s18, 67108864
    s_mov_b32 s19, 0x00020000
    s_mov_b32 s20, s8
    s_mov_b32 s21, s9
    s_mov_b32 s22, 67108864
    s_mov_b32 s23, 0x00020000
    s_add_u32 s24, s4, 8388608
    s_addc_u32 s25, s5, 0
    s_mov_b32 s26, 8388608
    s_mov_b32 s27, 0x00020000
    s_mov_b32 s44, s10
    s_mov_b32 s45, s11
    s_mov_b32 s46, 8388608
    s_mov_b32 s47, 0x00020000
    v_and_b32 v1, 31, v0
    s_lshr_b32 s39, s34, 2
    s_lshl_b32 s39, s39, 5
    v_add_u32 v1, s39, v1
    v_lshlrev_b32 v1, 13, v1
    v_lshrrev_b32 v2, 5, v0
    v_lshl_add_u32 v1, v2, 4, v1
    s_lshl_b32 s39, s42, 8
    v_add_u32 v8, s39, v1
    buffer_load_dwordx4 v[48:51], v8, s[12:15], 0 offen offset:0
    buffer_load_dwordx4 v[52:55], v8, s[12:15], 0 offen offset:32
    buffer_load_dwordx4 v[56:59], v8, s[12:15], 0 offen offset:64
    buffer_load_dwordx4 v[60:63], v8, s[12:15], 0 offen offset:96
    buffer_load_dwordx4 v[64:67], v8, s[12:15], 0 offen offset:128
    buffer_load_dwordx4 v[68:71], v8, s[12:15], 0 offen offset:160
    buffer_load_dwordx4 v[72:75], v8, s[12:15], 0 offen offset:192
    buffer_load_dwordx4 v[76:79], v8, s[12:15], 0 offen offset:224
    v_lshrrev_b32 v1, 4, v0
    v_and_b32 v2, 15, v0
    s_lshl_b32 s39, s30, 2
    v_add_u32 v3, s39, v1
    v_xor_b32 v4, v2, v3
    v_lshlrev_b32 v5, 8, v3
    v_lshl_add_u32 v24, v4, 4, v5
    v_add_u32 v25, 4096, v24
    v_lshlrev_b32 v4, 2, v1
    v_xor_b32 v4, v2, v4
    v_lshl_add_u32 v26, v4, 4, v5
    v_add_u32 v27, 4096, v26
    v_and_b32 v1, 31, v0
    v_lshrrev_b32 v2, 5, v0
    v_and_b32 v3, 15, v1
    v_xor_b32 v2, v2, v3
    v_lshlrev_b32 v1, 8, v1
    v_lshl_add_u32 v1, v2, 4, v1
    s_lshl_b32 s39, s29, 16
    v_add_u32 v28, s39, v1
    v_xor_b32 v29, 32, v28
    v_xor_b32 v30, 64, v28
    v_xor_b32 v31, 96, v28
    v_xor_b32 v32, 128, v28
    v_xor_b32 v33, 160, v28
    v_xor_b32 v34, 192, v28
    v_xor_b32 v35, 224, v28
    v_and_b32 v1, 15, v0
    v_lshrrev_b32 v2, 2, v1
    v_and_b32 v1, 3, v1
    v_lshrrev_b32 v3, 5, v0
    v_lshl_add_u32 v3, v3, 2, v2
    v_lshlrev_b32 v3, 8, v3
    v_lshl_add_u32 v3, v1, 3, v3
    v_lshrrev_b32 v1, 4, v0
    v_and_b32 v1, 1, v1
    v_lshl_add_u32 v3, v1, 5, v3
    v_lshl_add_u32 v3, v2, 6, v3
    s_lshl_b32 s39, s29, 16
    s_add_u32 s39, s39, 32768
    v_add_u32 v36, s39, v3
    v_xor_b32 v37, 64, v36
    v_xor_b32 v38, 128, v36
    v_xor_b32 v39, 192, v36
    v_mov_b32 v10, 0xff800000
    v_mov_b32 v12, 0
    v_mov_b32 v112, 0
    v_mov_b32 v113, 0
    v_mov_b32 v114, 0
    v_mov_b32 v115, 0
    v_mov_b32 v116, 0
    v_mov_b32 v117, 0
    v_mov_b32 v118, 0
    v_mov_b32 v119, 0
    v_mov_b32 v120, 0
    v_mov_b32 v121, 0
    v_mov_b32 v122, 0
    v_mov_b32 v123, 0
    v_mov_b32 v124, 0
    v_mov_b32 v125, 0
    v_mov_b32 v126, 0
    v_mov_b32 v127, 0
    v_mov_b32 v128, 0
    v_mov_b32 v129, 0
    v_mov_b32 v130, 0
    v_mov_b32 v131, 0
    v_mov_b32 v132, 0
    v_mov_b32 v133, 0
    v_mov_b32 v134, 0
    v_mov_b32 v135, 0
    v_mov_b32 v136, 0
    v_mov_b32 v137, 0
    v_mov_b32 v138, 0
    v_mov_b32 v139, 0
    v_mov_b32 v140, 0
    v_mov_b32 v141, 0
    v_mov_b32 v142, 0
    v_mov_b32 v143, 0
    v_mov_b32 v144, 0
    v_mov_b32 v145, 0
    v_mov_b32 v146, 0
    v_mov_b32 v147, 0
    v_mov_b32 v148, 0
    v_mov_b32 v149, 0
    v_mov_b32 v150, 0
    v_mov_b32 v151, 0
    v_mov_b32 v152, 0
    v_mov_b32 v153, 0
    v_mov_b32 v154, 0
    v_mov_b32 v155, 0
    v_mov_b32 v156, 0
    v_mov_b32 v157, 0
    v_mov_b32 v158, 0
    v_mov_b32 v159, 0
    v_mov_b32 v160, 0
    v_mov_b32 v161, 0
    v_mov_b32 v162, 0
    v_mov_b32 v163, 0
    v_mov_b32 v164, 0
    v_mov_b32 v165, 0
    v_mov_b32 v166, 0
    v_mov_b32 v167, 0
    v_mov_b32 v168, 0
    v_mov_b32 v169, 0
    v_mov_b32 v170, 0
    v_mov_b32 v171, 0
    v_mov_b32 v172, 0
    v_mov_b32 v173, 0
    v_mov_b32 v174, 0
    v_mov_b32 v175, 0
    s_add_u32 m0, s31, 0
    s_nop 0
    buffer_load_dwordx4 v24, s[16:19], s32 offen nt lds
    s_add_u32 m0, s31, 4096
    s_nop 0
    buffer_load_dwordx4 v25, s[16:19], s32 offen nt lds
    s_add_u32 s32, s32, 8192
    s_add_u32 m0, s31, 8192
    s_nop 0
    buffer_load_dwordx4 v24, s[16:19], s32 offen nt lds
    s_add_u32 m0, s31, 12288
    s_nop 0
    buffer_load_dwordx4 v25, s[16:19], s32 offen nt lds
    s_add_u32 s32, s32, 8192
    s_add_u32 m0, s31, 16384
    s_nop 0
    buffer_load_dwordx4 v24, s[16:19], s32 offen nt lds
    s_add_u32 m0, s31, 20480
    s_nop 0
    buffer_load_dwordx4 v25, s[16:19], s32 offen nt lds
    s_add_u32 s32, s32, 8192
    s_add_u32 m0, s31, 32768
    s_nop 0
    buffer_load_dwordx4 v26, s[20:23], s33 offen nt lds
    s_add_u32 m0, s31, 36864
    s_nop 0
    buffer_load_dwordx4 v27, s[20:23], s33 offen nt lds
    s_add_u32 s33, s33, 8192
    s_waitcnt vmcnt(6) lgkmcnt(0)
    s_barrier
    ds_read_b128 v[176:179], v28 offset:0
    ds_read_b128 v[180:183], v29 offset:0
    ds_read_b128 v[184:187], v30 offset:0
    ds_read_b128 v[188:191], v31 offset:0
    ds_read_b128 v[192:195], v32 offset:0
    ds_read_b128 v[196:199], v33 offset:0
    ds_read_b128 v[200:203], v34 offset:0
    ds_read_b128 v[204:207], v35 offset:0
    s_add_u32 m0, s31, 24576
    s_nop 0
    buffer_load_dwordx4 v24, s[16:19], s32 offen nt lds
    s_add_u32 m0, s31, 28672
    s_nop 0
    buffer_load_dwordx4 v25, s[16:19], s32 offen nt lds
    s_add_u32 s32, s32, 8192
    s_add_u32 m0, s31, 40960
    s_nop 0
    buffer_load_dwordx4 v26, s[20:23], s33 offen nt lds
    s_add_u32 m0, s31, 45056
    s_nop 0
    buffer_load_dwordx4 v27, s[20:23], s33 offen nt lds
    s_add_u32 s33, s33, 8192
    s_waitcnt vmcnt(8) lgkmcnt(0)
    s_barrier
    v_mfma_f32_32x32x16_bf16 v[80:95], v[176:179], v[48:51], 0
    v_mfma_f32_32x32x16_bf16 v[80:95], v[180:183], v[52:55], v[80:95]
    v_mfma_f32_32x32x16_bf16 v[80:95], v[184:187], v[56:59], v[80:95]
    v_mfma_f32_32x32x16_bf16 v[80:95], v[188:191], v[60:63], v[80:95]
    v_mfma_f32_32x32x16_bf16 v[80:95], v[192:195], v[64:67], v[80:95]
    v_mfma_f32_32x32x16_bf16 v[80:95], v[196:199], v[68:71], v[80:95]
    v_mfma_f32_32x32x16_bf16 v[80:95], v[200:203], v[72:75], v[80:95]
    v_mfma_f32_32x32x16_bf16 v[80:95], v[204:207], v[76:79], v[80:95]
    ds_read_b128 v[176:179], v28 offset:8192
    ds_read_b128 v[180:183], v29 offset:8192
    ds_read_b128 v[184:187], v30 offset:8192
    ds_read_b128 v[188:191], v31 offset:8192
    ds_read_b128 v[192:195], v32 offset:8192
    ds_read_b128 v[196:199], v33 offset:8192
    ds_read_b128 v[200:203], v34 offset:8192
    ds_read_b128 v[204:207], v35 offset:8192
    s_add_u32 m0, s31, 0
    s_nop 0
    buffer_load_dwordx4 v24, s[16:19], s32 offen nt lds
    s_add_u32 m0, s31, 4096
    s_nop 0
    buffer_load_dwordx4 v25, s[16:19], s32 offen nt lds
    s_add_u32 s32, s32, 8192
    s_add_u32 m0, s31, 49152
    s_nop 0
    buffer_load_dwordx4 v26, s[20:23], s33 offen nt lds
    s_add_u32 m0, s31, 53248
    s_nop 0
    buffer_load_dwordx4 v27, s[20:23], s33 offen nt lds
    s_add_u32 s33, s33, 8192
    s_mov_b32 s38, 6
L_gqa_attn_kernel_loop:
    s_waitcnt vmcnt(8) lgkmcnt(0)
    s_barrier
    v_mfma_f32_32x32x16_bf16 v[96:111], v[176:179], v[48:51], 0
    v_max3_f32 v1, v80, v81, v82
    ds_read_b64_tr_b16 v[208:209], v36 offset:0
    v_max3_f32 v2, v83, v84, v85
    v_max3_f32 v3, v86, v87, v88
    v_max3_f32 v4, v89, v90, v91
    v_max3_f32 v1, v1, v92, v93
    ds_read_b64_tr_b16 v[210:211], v36 offset:2048
    v_max3_f32 v2, v2, v94, v95
    v_max3_f32 v1, v1, v2, v3
    v_max_f32 v1, v1, v4
    v_mfma_f32_32x32x16_bf16 v[96:111], v[180:183], v[52:55], v[96:111]
    v_mov_b32 v2, v1
    s_nop 1
    v_permlane32_swap_b32 v1, v2
    ds_read_b64_tr_b16 v[212:213], v37 offset:0
    v_max_f32 v1, v1, v2
    v_mul_f32 v1, s36, v1
    v_sub_f32 v3, v1, v10
    v_cmp_lt_f32 vcc, s37, v3
    s_cbranch_vccz L_gqa_attn_kernel_skip1
    v_max_f32 v4, v10, v1
    v_sub_f32 v3, v10, v4
    v_exp_f32 v3, v3
    v_mov_b32 v10, v4
    s_nop 7
    v_mul_f32 v12, v12, v3
    v_mul_f32 v112, v112, v3
    v_mul_f32 v113, v113, v3
    v_mul_f32 v114, v114, v3
    v_mul_f32 v115, v115, v3
    v_mul_f32 v116, v116, v3
    v_mul_f32 v117, v117, v3
    v_mul_f32 v118, v118, v3
    v_mul_f32 v119, v119, v3
    v_mul_f32 v120, v120, v3
    v_mul_f32 v121, v121, v3
    v_mul_f32 v122, v122, v3
    v_mul_f32 v123, v123, v3
    v_mul_f32 v124, v124, v3
    v_mul_f32 v125, v125, v3
    v_mul_f32 v126, v126, v3
    v_mul_f32 v127, v127, v3
    v_mul_f32 v128, v128, v3
    v_mul_f32 v129, v129, v3
    v_mul_f32 v130, v130, v3
    v_mul_f32 v131, v131, v3
    v_mul_f32 v132, v132, v3
    v_mul_f32 v133, v133, v3
    v_mul_f32 v134, v134, v3
    v_mul_f32 v135, v135, v3
    v_mul_f32 v136, v136, v3
    v_mul_f32 v137, v137, v3
    v_mul_f32 v138, v138, v3
    v_mul_f32 v139, v139, v3
    v_mul_f32 v140, v140, v3
    v_mul_f32 v141, v141, v3
    v_mul_f32 v142, v142, v3
    v_mul_f32 v143, v143, v3
    v_mul_f32 v144, v144, v3
    v_mul_f32 v145, v145, v3
    v_mul_f32 v146, v146, v3
    v_mul_f32 v147, v147, v3
    v_mul_f32 v148, v148, v3
    v_mul_f32 v149, v149, v3
    v_mul_f32 v150, v150, v3
    v_mul_f32 v151, v151, v3
    v_mul_f32 v152, v152, v3
    v_mul_f32 v153, v153, v3
    v_mul_f32 v154, v154, v3
    v_mul_f32 v155, v155, v3
    v_mul_f32 v156, v156, v3
    v_mul_f32 v157, v157, v3
    v_mul_f32 v158, v158, v3
    v_mul_f32 v159, v159, v3
    v_mul_f32 v160, v160, v3
    v_mul_f32 v161, v161, v3
    v_mul_f32 v162, v162, v3
    v_mul_f32 v163, v163, v3
    v_mul_f32 v164, v164, v3
    v_mul_f32 v165, v165, v3
    v_mul_f32 v166, v166, v3
    v_mul_f32 v167, v167, v3
    v_mul_f32 v168, v168, v3
    v_mul_f32 v169, v169, v3
    v_mul_f32 v170, v170, v3
    v_mul_f32 v171, v171, v3
    v_mul_f32 v172, v172, v3
    v_mul_f32 v173, v173, v3
    v_mul_f32 v174, v174, v3
    v_mul_f32 v175, v175, v3
    s_nop 1
L_gqa_attn_kernel_skip1:
    ds_read_b64_tr_b16 v[214:215], v37 offset:2048
    v_fma_f32 v80, v80, s36, -v10
    v_fma_f32 v81, v81, s36, -v10
    v_fma_f32 v82, v82, s36, -v10
    v_fma_f32 v83, v83, s36, -v10
    v_mfma_f32_32x32x16_bf16 v[96:111], v[184:187], v[56:59], v[96:111]
    v_fma_f32 v84, v84, s36, -v10
    ds_read_b64_tr_b16 v[216:217], v38 offset:0
    v_fma_f32 v85, v85, s36, -v10
    v_fma_f32 v86, v86, s36, -v10
    v_fma_f32 v87, v87, s36, -v10
    v_fma_f32 v88, v88, s36, -v10
    ds_read_b64_tr_b16 v[218:219], v38 offset:2048
    v_fma_f32 v89, v89, s36, -v10
    v_fma_f32 v90, v90, s36, -v10
    v_fma_f32 v91, v91, s36, -v10
    v_mfma_f32_32x32x16_bf16 v[96:111], v[188:191], v[60:63], v[96:111]
    v_fma_f32 v92, v92, s36, -v10
    ds_read_b64_tr_b16 v[220:221], v39 offset:0
    v_fma_f32 v93, v93, s36, -v10
    v_fma_f32 v94, v94, s36, -v10
    v_fma_f32 v95, v95, s36, -v10
    v_exp_f32 v80, v80
    v_exp_f32 v81, v81
    ds_read_b64_tr_b16 v[222:223], v39 offset:2048
    v_exp_f32 v82, v82
    v_exp_f32 v83, v83
    v_exp_f32 v84, v84
    v_mfma_f32_32x32x16_bf16 v[96:111], v[192:195], v[64:67], v[96:111]
    v_exp_f32 v85, v85
    s_waitcnt lgkmcnt(7)
    ds_read_b64_tr_b16 v[224:225], v36 offset:4096
    v_exp_f32 v86, v86
    v_exp_f32 v87, v87
    v_exp_f32 v88, v88
    v_exp_f32 v89, v89
    ds_read_b64_tr_b16 v[226:227], v36 offset:6144
    v_exp_f32 v90, v90
    v_exp_f32 v91, v91
    v_exp_f32 v92, v92
    v_exp_f32 v93, v93
    v_mfma_f32_32x32x16_bf16 v[96:111], v[196:199], v[68:71], v[96:111]
    v_exp_f32 v94, v94
    ds_read_b64_tr_b16 v[228:229], v37 offset:4096
    v_exp_f32 v95, v95
    v_cvt_pk_bf16_f32 v40, v80, v81
    v_cvt_pk_bf16_f32 v41, v82, v83
    v_cvt_pk_bf16_f32 v42, v84, v85
    ds_read_b64_tr_b16 v[230:231], v37 offset:6144
    v_cvt_pk_bf16_f32 v43, v86, v87
    v_cvt_pk_bf16_f32 v44, v88, v89
    v_cvt_pk_bf16_f32 v45, v90, v91
    v_mfma_f32_32x32x16_bf16 v[96:111], v[200:203], v[72:75], v[96:111]
    v_cvt_pk_bf16_f32 v46, v92, v93
    ds_read_b64_tr_b16 v[232:233], v38 offset:4096
    v_cvt_pk_bf16_f32 v47, v94, v95
    v_add_f32 v1, v80, v81
    v_add_f32 v2, v82, v83
    v_add_f32 v3, v84, v85
    v_add_f32 v4, v86, v87
    ds_read_b64_tr_b16 v[234:235], v38 offset:6144
    v_add_f32 v1, v1, v88
    v_add_f32 v2, v2, v89
    v_add_f32 v3, v3, v90
    v_mfma_f32_32x32x16_bf16 v[96:111], v[204:207], v[76:79], v[96:111]
    v_add_f32 v4, v4, v91
    ds_read_b64_tr_b16 v[236:237], v39 offset:4096
    v_add_f32 v1, v1, v92
    v_add_f32 v2, v2, v93
    v_add_f32 v3, v3, v94
    v_add_f32 v4, v4, v95
    ds_read_b64_tr_b16 v[238:239], v39 offset:6144
    v_add_f32 v1, v1, v2
    v_add_f32 v3, v3, v4
    v_add_f32 v1, v1, v3
    v_add_f32 v12, v12, v1
    s_waitcnt lgkmcnt(0)
    ds_read_b128 v[176:179], v28 offset:16384
    ds_read_b128 v[180:183], v29 offset:16384
    v_mfma_f32_32x32x16_bf16 v[112:127], v[208:211], v[40:43], v[112:127]
    ds_read_b128 v[184:187], v30 offset:16384
    ds_read_b128 v[188:191], v31 offset:16384
    v_mfma_f32_32x32x16_bf16 v[128:143], v[212:215], v[40:43], v[128:143]
    ds_read_b128 v[192:195], v32 offset:16384
    ds_read_b128 v[196:199], v33 offset:16384
    v_mfma_f32_32x32x16_bf16 v[144:159], v[216:219], v[40:43], v[144:159]
    ds_read_b128 v[200:203], v34 offset:16384
    ds_read_b128 v[204:207], v35 offset:16384
    v_mfma_f32_32x32x16_bf16 v[160:175], v[220:223], v[40:43], v[160:175]
    v_mfma_f32_32x32x16_bf16 v[112:127], v[224:227], v[44:47], v[112:127]
    s_add_u32 m0, s31, 8192
    s_nop 0
    buffer_load_dwordx4 v24, s[16:19], s32 offen nt lds
    v_mfma_f32_32x32x16_bf16 v[128:143], v[228:231], v[44:47], v[128:143]
    s_add_u32 m0, s31, 12288
    s_nop 0
    buffer_load_dwordx4 v25, s[16:19], s32 offen nt lds
    s_add_u32 s32, s32, 8192
    v_mfma_f32_32x32x16_bf16 v[144:159], v[232:235], v[44:47], v[144:159]
    s_add_u32 m0, s31, 57344
    s_nop 0
    buffer_load_dwordx4 v26, s[20:23], s33 offen nt lds
    v_mfma_f32_32x32x16_bf16 v[160:175], v[236:239], v[44:47], v[160:175]
    s_add_u32 m0, s31, 61440
    s_nop 0
    buffer_load_dwordx4 v27, s[20:23], s33 offen nt lds
    s_add_u32 s33, s33, 8192
    s_waitcnt vmcnt(8) lgkmcnt(0)
    s_barrier
    v_mfma_f32_32x32x16_bf16 v[80:95], v[176:179], v[48:51], 0
    v_max3_f32 v1, v96, v97, v98
    ds_read_b64_tr_b16 v[208:209], v36 offset:8192
    v_max3_f32 v2, v99, v100, v101
    v_max3_f32 v3, v102, v103, v104
    v_max3_f32 v4, v105, v106, v107
    v_max3_f32 v1, v1, v108, v109
    ds_read_b64_tr_b16 v[210:211], v36 offset:10240
    v_max3_f32 v2, v2, v110, v111
    v_max3_f32 v1, v1, v2, v3
    v_max_f32 v1, v1, v4
    v_mfma_f32_32x32x16_bf16 v[80:95], v[180:183], v[52:55], v[80:95]
    v_mov_b32 v2, v1
    s_nop 1
    v_permlane32_swap_b32 v1, v2
    ds_read_b64_tr_b16 v[212:213], v37 offset:8192
    v_max_f32 v1, v1, v2
    v_mul_f32 v1, s36, v1
    v_sub_f32 v3, v1, v10
    v_cmp_lt_f32 vcc, s37, v3
    s_cbranch_vccz L_gqa_attn_kernel_skip2
    v_max_f32 v4, v10, v1
    v_sub_f32 v3, v10, v4
    v_exp_f32 v3, v3
    v_mov_b32 v10, v4
    s_nop 7
    v_mul_f32 v12, v12, v3
    v_mul_f32 v112, v112, v3
    v_mul_f32 v113, v113, v3
    v_mul_f32 v114, v114, v3
    v_mul_f32 v115, v115, v3
    v_mul_f32 v116, v116, v3
    v_mul_f32 v117, v117, v3
    v_mul_f32 v118, v118, v3
    v_mul_f32 v119, v119, v3
    v_mul_f32 v120, v120, v3
    v_mul_f32 v121, v121, v3
    v_mul_f32 v122, v122, v3
    v_mul_f32 v123, v123, v3
    v_mul_f32 v124, v124, v3
    v_mul_f32 v125, v125, v3
    v_mul_f32 v126, v126, v3
    v_mul_f32 v127, v127, v3
    v_mul_f32 v128, v128, v3
    v_mul_f32 v129, v129, v3
    v_mul_f32 v130, v130, v3
    v_mul_f32 v131, v131, v3
    v_mul_f32 v132, v132, v3
    v_mul_f32 v133, v133, v3
    v_mul_f32 v134, v134, v3
    v_mul_f32 v135, v135, v3
    v_mul_f32 v136, v136, v3
    v_mul_f32 v137, v137, v3
    v_mul_f32 v138, v138, v3
    v_mul_f32 v139, v139, v3
    v_mul_f32 v140, v140, v3
    v_mul_f32 v141, v141, v3
    v_mul_f32 v142, v142, v3
    v_mul_f32 v143, v143, v3
    v_mul_f32 v144, v144, v3
    v_mul_f32 v145, v145, v3
    v_mul_f32 v146, v146, v3
    v_mul_f32 v147, v147, v3
    v_mul_f32 v148, v148, v3
    v_mul_f32 v149, v149, v3
    v_mul_f32 v150, v150, v3
    v_mul_f32 v151, v151, v3
    v_mul_f32 v152, v152, v3
    v_mul_f32 v153, v153, v3
    v_mul_f32 v154, v154, v3
    v_mul_f32 v155, v155, v3
    v_mul_f32 v156, v156, v3
    v_mul_f32 v157, v157, v3
    v_mul_f32 v158, v158, v3
    v_mul_f32 v159, v159, v3
    v_mul_f32 v160, v160, v3
    v_mul_f32 v161, v161, v3
    v_mul_f32 v162, v162, v3
    v_mul_f32 v163, v163, v3
    v_mul_f32 v164, v164, v3
    v_mul_f32 v165, v165, v3
    v_mul_f32 v166, v166, v3
    v_mul_f32 v167, v167, v3
    v_mul_f32 v168, v168, v3
    v_mul_f32 v169, v169, v3
    v_mul_f32 v170, v170, v3
    v_mul_f32 v171, v171, v3
    v_mul_f32 v172, v172, v3
    v_mul_f32 v173, v173, v3
    v_mul_f32 v174, v174, v3
    v_mul_f32 v175, v175, v3
    s_nop 1
L_gqa_attn_kernel_skip2:
    ds_read_b64_tr_b16 v[214:215], v37 offset:10240
    v_fma_f32 v96, v96, s36, -v10
    v_fma_f32 v97, v97, s36, -v10
    v_fma_f32 v98, v98, s36, -v10
    v_fma_f32 v99, v99, s36, -v10
    v_mfma_f32_32x32x16_bf16 v[80:95], v[184:187], v[56:59], v[80:95]
    v_fma_f32 v100, v100, s36, -v10
    ds_read_b64_tr_b16 v[216:217], v38 offset:8192
    v_fma_f32 v101, v101, s36, -v10
    v_fma_f32 v102, v102, s36, -v10
    v_fma_f32 v103, v103, s36, -v10
    v_fma_f32 v104, v104, s36, -v10
    ds_read_b64_tr_b16 v[218:219], v38 offset:10240
    v_fma_f32 v105, v105, s36, -v10
    v_fma_f32 v106, v106, s36, -v10
    v_fma_f32 v107, v107, s36, -v10
    v_mfma_f32_32x32x16_bf16 v[80:95], v[188:191], v[60:63], v[80:95]
    v_fma_f32 v108, v108, s36, -v10
    ds_read_b64_tr_b16 v[220:221], v39 offset:8192
    v_fma_f32 v109, v109, s36, -v10
    v_fma_f32 v110, v110, s36, -v10
    v_fma_f32 v111, v111, s36, -v10
    v_exp_f32 v96, v96
    v_exp_f32 v97, v97
    ds_read_b64_tr_b16 v[222:223], v39 offset:10240
    v_exp_f32 v98, v98
    v_exp_f32 v99, v99
    v_exp_f32 v100, v100
    v_mfma_f32_32x32x16_bf16 v[80:95], v[192:195], v[64:67], v[80:95]
    v_exp_f32 v101, v101
    s_waitcnt lgkmcnt(7)
    ds_read_b64_tr_b16 v[224:225], v36 offset:12288
    v_exp_f32 v102, v102
    v_exp_f32 v103, v103
    v_exp_f32 v104, v104
    v_exp_f32 v105, v105
    ds_read_b64_tr_b16 v[226:227], v36 offset:14336
    v_exp_f32 v106, v106
    v_exp_f32 v107, v107
    v_exp_f32 v108, v108
    v_exp_f32 v109, v109
    v_mfma_f32_32x32x16_bf16 v[80:95], v[196:199], v[68:71], v[80:95]
    v_exp_f32 v110, v110
    ds_read_b64_tr_b16 v[228:229], v37 offset:12288
    v_exp_f32 v111, v111
    v_cvt_pk_bf16_f32 v40, v96, v97
    v_cvt_pk_bf16_f32 v41, v98, v99
    v_cvt_pk_bf16_f32 v42, v100, v101
    ds_read_b64_tr_b16 v[230:231], v37 offset:14336
    v_cvt_pk_bf16_f32 v43, v102, v103
    v_cvt_pk_bf16_f32 v44, v104, v105
    v_cvt_pk_bf16_f32 v45, v106, v107
    v_mfma_f32_32x32x16_bf16 v[80:95], v[200:203], v[72:75], v[80:95]
    v_cvt_pk_bf16_f32 v46, v108, v109
    ds_read_b64_tr_b16 v[232:233], v38 offset:12288
    v_cvt_pk_bf16_f32 v47, v110, v111
    v_add_f32 v1, v96, v97
    v_add_f32 v2, v98, v99
    v_add_f32 v3, v100, v101
    v_add_f32 v4, v102, v103
    ds_read_b64_tr_b16 v[234:235], v38 offset:14336
    v_add_f32 v1, v1, v104
    v_add_f32 v2, v2, v105
    v_add_f32 v3, v3, v106
    v_mfma_f32_32x32x16_bf16 v[80:95], v[204:207], v[76:79], v[80:95]
    v_add_f32 v4, v4, v107
    ds_read_b64_tr_b16 v[236:237], v39 offset:12288
    v_add_f32 v1, v1, v108
    v_add_f32 v2, v2, v109
    v_add_f32 v3, v3, v110
    v_add_f32 v4, v4, v111
    ds_read_b64_tr_b16 v[238:239], v39 offset:14336
    v_add_f32 v1, v1, v2
    v_add_f32 v3, v3, v4
    v_add_f32 v1, v1, v3
    v_add_f32 v12, v12, v1
    s_waitcnt lgkmcnt(0)
    ds_read_b128 v[176:179], v28 offset:24576
    ds_read_b128 v[180:183], v29 offset:24576
    v_mfma_f32_32x32x16_bf16 v[112:127], v[208:211], v[40:43], v[112:127]
    ds_read_b128 v[184:187], v30 offset:24576
    ds_read_b128 v[188:191], v31 offset:24576
    v_mfma_f32_32x32x16_bf16 v[128:143], v[212:215], v[40:43], v[128:143]
    ds_read_b128 v[192:195], v32 offset:24576
    ds_read_b128 v[196:199], v33 offset:24576
    v_mfma_f32_32x32x16_bf16 v[144:159], v[216:219], v[40:43], v[144:159]
    ds_read_b128 v[200:203], v34 offset:24576
    ds_read_b128 v[204:207], v35 offset:24576
    v_mfma_f32_32x32x16_bf16 v[160:175], v[220:223], v[40:43], v[160:175]
    v_mfma_f32_32x32x16_bf16 v[112:127], v[224:227], v[44:47], v[112:127]
    s_add_u32 m0, s31, 16384
    s_nop 0
    buffer_load_dwordx4 v24, s[16:19], s32 offen nt lds
    v_mfma_f32_32x32x16_bf16 v[128:143], v[228:231], v[44:47], v[128:143]
    s_add_u32 m0, s31, 20480
    s_nop 0
    buffer_load_dwordx4 v25, s[16:19], s32 offen nt lds
    s_add_u32 s32, s32, 8192
    v_mfma_f32_32x32x16_bf16 v[144:159], v[232:235], v[44:47], v[144:159]
    s_add_u32 m0, s31, 32768
    s_nop 0
    buffer_load_dwordx4 v26, s[20:23], s33 offen nt lds
    v_mfma_f32_32x32x16_bf16 v[160:175], v[236:239], v[44:47], v[160:175]
    s_add_u32 m0, s31, 36864
    s_nop 0
    buffer_load_dwordx4 v27, s[20:23], s33 offen nt lds
    s_add_u32 s33, s33, 8192
    s_waitcnt vmcnt(8) lgkmcnt(0)
    s_barrier
    v_mfma_f32_32x32x16_bf16 v[96:111], v[176:179], v[48:51], 0
    v_max3_f32 v1, v80, v81, v82
    ds_read_b64_tr_b16 v[208:209], v36 offset:16384
    v_max3_f32 v2, v83, v84, v85
    v_max3_f32 v3, v86, v87, v88
    v_max3_f32 v4, v89, v90, v91
    v_max3_f32 v1, v1, v92, v93
    ds_read_b64_tr_b16 v[210:211], v36 offset:18432
    v_max3_f32 v2, v2, v94, v95
    v_max3_f32 v1, v1, v2, v3
    v_max_f32 v1, v1, v4
    v_mfma_f32_32x32x16_bf16 v[96:111], v[180:183], v[52:55], v[96:111]
    v_mov_b32 v2, v1
    s_nop 1
    v_permlane32_swap_b32 v1, v2
    ds_read_b64_tr_b16 v[212:213], v37 offset:16384
    v_max_f32 v1, v1, v2
    v_mul_f32 v1, s36, v1
    v_sub_f32 v3, v1, v10
    v_cmp_lt_f32 vcc, s37, v3
    s_cbranch_vccz L_gqa_attn_kernel_skip3
    v_max_f32 v4, v10, v1
    v_sub_f32 v3, v10, v4
    v_exp_f32 v3, v3
    v_mov_b32 v10, v4
    s_nop 7
    v_mul_f32 v12, v12, v3
    v_mul_f32 v112, v112, v3
    v_mul_f32 v113, v113, v3
    v_mul_f32 v114, v114, v3
    v_mul_f32 v115, v115, v3
    v_mul_f32 v116, v116, v3
    v_mul_f32 v117, v117, v3
    v_mul_f32 v118, v118, v3
    v_mul_f32 v119, v119, v3
    v_mul_f32 v120, v120, v3
    v_mul_f32 v121, v121, v3
    v_mul_f32 v122, v122, v3
    v_mul_f32 v123, v123, v3
    v_mul_f32 v124, v124, v3
    v_mul_f32 v125, v125, v3
    v_mul_f32 v126, v126, v3
    v_mul_f32 v127, v127, v3
    v_mul_f32 v128, v128, v3
    v_mul_f32 v129, v129, v3
    v_mul_f32 v130, v130, v3
    v_mul_f32 v131, v131, v3
    v_mul_f32 v132, v132, v3
    v_mul_f32 v133, v133, v3
    v_mul_f32 v134, v134, v3
    v_mul_f32 v135, v135, v3
    v_mul_f32 v136, v136, v3
    v_mul_f32 v137, v137, v3
    v_mul_f32 v138, v138, v3
    v_mul_f32 v139, v139, v3
    v_mul_f32 v140, v140, v3
    v_mul_f32 v141, v141, v3
    v_mul_f32 v142, v142, v3
    v_mul_f32 v143, v143, v3
    v_mul_f32 v144, v144, v3
    v_mul_f32 v145, v145, v3
    v_mul_f32 v146, v146, v3
    v_mul_f32 v147, v147, v3
    v_mul_f32 v148, v148, v3
    v_mul_f32 v149, v149, v3
    v_mul_f32 v150, v150, v3
    v_mul_f32 v151, v151, v3
    v_mul_f32 v152, v152, v3
    v_mul_f32 v153, v153, v3
    v_mul_f32 v154, v154, v3
    v_mul_f32 v155, v155, v3
    v_mul_f32 v156, v156, v3
    v_mul_f32 v157, v157, v3
    v_mul_f32 v158, v158, v3
    v_mul_f32 v159, v159, v3
    v_mul_f32 v160, v160, v3
    v_mul_f32 v161, v161, v3
    v_mul_f32 v162, v162, v3
    v_mul_f32 v163, v163, v3
    v_mul_f32 v164, v164, v3
    v_mul_f32 v165, v165, v3
    v_mul_f32 v166, v166, v3
    v_mul_f32 v167, v167, v3
    v_mul_f32 v168, v168, v3
    v_mul_f32 v169, v169, v3
    v_mul_f32 v170, v170, v3
    v_mul_f32 v171, v171, v3
    v_mul_f32 v172, v172, v3
    v_mul_f32 v173, v173, v3
    v_mul_f32 v174, v174, v3
    v_mul_f32 v175, v175, v3
    s_nop 1
L_gqa_attn_kernel_skip3:
    ds_read_b64_tr_b16 v[214:215], v37 offset:18432
    v_fma_f32 v80, v80, s36, -v10
    v_fma_f32 v81, v81, s36, -v10
    v_fma_f32 v82, v82, s36, -v10
    v_fma_f32 v83, v83, s36, -v10
    v_mfma_f32_32x32x16_bf16 v[96:111], v[184:187], v[56:59], v[96:111]
    v_fma_f32 v84, v84, s36, -v10
    ds_read_b64_tr_b16 v[216:217], v38 offset:16384
    v_fma_f32 v85, v85, s36, -v10
    v_fma_f32 v86, v86, s36, -v10
    v_fma_f32 v87, v87, s36, -v10
    v_fma_f32 v88, v88, s36, -v10
    ds_read_b64_tr_b16 v[218:219], v38 offset:18432
    v_fma_f32 v89, v89, s36, -v10
    v_fma_f32 v90, v90, s36, -v10
    v_fma_f32 v91, v91, s36, -v10
    v_mfma_f32_32x32x16_bf16 v[96:111], v[188:191], v[60:63], v[96:111]
    v_fma_f32 v92, v92, s36, -v10
    ds_read_b64_tr_b16 v[220:221], v39 offset:16384
    v_fma_f32 v93, v93, s36, -v10
    v_fma_f32 v94, v94, s36, -v10
    v_fma_f32 v95, v95, s36, -v10
    v_exp_f32 v80, v80
    v_exp_f32 v81, v81
    ds_read_b64_tr_b16 v[222:223], v39 offset:18432
    v_exp_f32 v82, v82
    v_exp_f32 v83, v83
    v_exp_f32 v84, v84
    v_mfma_f32_32x32x16_bf16 v[96:111], v[192:195], v[64:67], v[96:111]
    v_exp_f32 v85, v85
    s_waitcnt lgkmcnt(7)
    ds_read_b64_tr_b16 v[224:225], v36 offset:20480
    v_exp_f32 v86, v86
    v_exp_f32 v87, v87
    v_exp_f32 v88, v88
    v_exp_f32 v89, v89
    ds_read_b64_tr_b16 v[226:227], v36 offset:22528
    v_exp_f32 v90, v90
    v_exp_f32 v91, v91
    v_exp_f32 v92, v92
    v_exp_f32 v93, v93
    v_mfma_f32_32x32x16_bf16 v[96:111], v[196:199], v[68:71], v[96:111]
    v_exp_f32 v94, v94
    ds_read_b64_tr_b16 v[228:229], v37 offset:20480
    v_exp_f32 v95, v95
    v_cvt_pk_bf16_f32 v40, v80, v81
    v_cvt_pk_bf16_f32 v41, v82, v83
    v_cvt_pk_bf16_f32 v42, v84, v85
    ds_read_b64_tr_b16 v[230:231], v37 offset:22528
    v_cvt_pk_bf16_f32 v43, v86, v87
    v_cvt_pk_bf16_f32 v44, v88, v89
    v_cvt_pk_bf16_f32 v45, v90, v91
    v_mfma_f32_32x32x16_bf16 v[96:111], v[200:203], v[72:75], v[96:111]
    v_cvt_pk_bf16_f32 v46, v92, v93
    ds_read_b64_tr_b16 v[232:233], v38 offset:20480
    v_cvt_pk_bf16_f32 v47, v94, v95
    v_add_f32 v1, v80, v81
    v_add_f32 v2, v82, v83
    v_add_f32 v3, v84, v85
    v_add_f32 v4, v86, v87
    ds_read_b64_tr_b16 v[234:235], v38 offset:22528
    v_add_f32 v1, v1, v88
    v_add_f32 v2, v2, v89
    v_add_f32 v3, v3, v90
    v_mfma_f32_32x32x16_bf16 v[96:111], v[204:207], v[76:79], v[96:111]
    v_add_f32 v4, v4, v91
    ds_read_b64_tr_b16 v[236:237], v39 offset:20480
    v_add_f32 v1, v1, v92
    v_add_f32 v2, v2, v93
    v_add_f32 v3, v3, v94
    v_add_f32 v4, v4, v95
    ds_read_b64_tr_b16 v[238:239], v39 offset:22528
    v_add_f32 v1, v1, v2
    v_add_f32 v3, v3, v4
    v_add_f32 v1, v1, v3
    v_add_f32 v12, v12, v1
    s_waitcnt lgkmcnt(0)
    ds_read_b128 v[176:179], v28 offset:0
    ds_read_b128 v[180:183], v29 offset:0
    v_mfma_f32_32x32x16_bf16 v[112:127], v[208:211], v[40:43], v[112:127]
    ds_read_b128 v[184:187], v30 offset:0
    ds_read_b128 v[188:191], v31 offset:0
    v_mfma_f32_32x32x16_bf16 v[128:143], v[212:215], v[40:43], v[128:143]
    ds_read_b128 v[192:195], v32 offset:0
    ds_read_b128 v[196:199], v33 offset:0
    v_mfma_f32_32x32x16_bf16 v[144:159], v[216:219], v[40:43], v[144:159]
    ds_read_b128 v[200:203], v34 offset:0
    ds_read_b128 v[204:207], v35 offset:0
    v_mfma_f32_32x32x16_bf16 v[160:175], v[220:223], v[40:43], v[160:175]
    v_mfma_f32_32x32x16_bf16 v[112:127], v[224:227], v[44:47], v[112:127]
    s_add_u32 m0, s31, 24576
    s_nop 0
    buffer_load_dwordx4 v24, s[16:19], s32 offen nt lds
    v_mfma_f32_32x32x16_bf16 v[128:143], v[228:231], v[44:47], v[128:143]
    s_add_u32 m0, s31, 28672
    s_nop 0
    buffer_load_dwordx4 v25, s[16:19], s32 offen nt lds
    s_add_u32 s32, s32, 8192
    v_mfma_f32_32x32x16_bf16 v[144:159], v[232:235], v[44:47], v[144:159]
    s_add_u32 m0, s31, 40960
    s_nop 0
    buffer_load_dwordx4 v26, s[20:23], s33 offen nt lds
    v_mfma_f32_32x32x16_bf16 v[160:175], v[236:239], v[44:47], v[160:175]
    s_add_u32 m0, s31, 45056
    s_nop 0
    buffer_load_dwordx4 v27, s[20:23], s33 offen nt lds
    s_add_u32 s33, s33, 8192
    s_waitcnt vmcnt(8) lgkmcnt(0)
    s_barrier
    v_mfma_f32_32x32x16_bf16 v[80:95], v[176:179], v[48:51], 0
    v_max3_f32 v1, v96, v97, v98
    ds_read_b64_tr_b16 v[208:209], v36 offset:24576
    v_max3_f32 v2, v99, v100, v101
    v_max3_f32 v3, v102, v103, v104
    v_max3_f32 v4, v105, v106, v107
    v_max3_f32 v1, v1, v108, v109
    ds_read_b64_tr_b16 v[210:211], v36 offset:26624
    v_max3_f32 v2, v2, v110, v111
    v_max3_f32 v1, v1, v2, v3
    v_max_f32 v1, v1, v4
    v_mfma_f32_32x32x16_bf16 v[80:95], v[180:183], v[52:55], v[80:95]
    v_mov_b32 v2, v1
    s_nop 1
    v_permlane32_swap_b32 v1, v2
    ds_read_b64_tr_b16 v[212:213], v37 offset:24576
    v_max_f32 v1, v1, v2
    v_mul_f32 v1, s36, v1
    v_sub_f32 v3, v1, v10
    v_cmp_lt_f32 vcc, s37, v3
    s_cbranch_vccz L_gqa_attn_kernel_skip4
    v_max_f32 v4, v10, v1
    v_sub_f32 v3, v10, v4
    v_exp_f32 v3, v3
    v_mov_b32 v10, v4
    s_nop 7
    v_mul_f32 v12, v12, v3
    v_mul_f32 v112, v112, v3
    v_mul_f32 v113, v113, v3
    v_mul_f32 v114, v114, v3
    v_mul_f32 v115, v115, v3
    v_mul_f32 v116, v116, v3
    v_mul_f32 v117, v117, v3
    v_mul_f32 v118, v118, v3
    v_mul_f32 v119, v119, v3
    v_mul_f32 v120, v120, v3
    v_mul_f32 v121, v121, v3
    v_mul_f32 v122, v122, v3
    v_mul_f32 v123, v123, v3
    v_mul_f32 v124, v124, v3
    v_mul_f32 v125, v125, v3
    v_mul_f32 v126, v126, v3
    v_mul_f32 v127, v127, v3
    v_mul_f32 v128, v128, v3
    v_mul_f32 v129, v129, v3
    v_mul_f32 v130, v130, v3
    v_mul_f32 v131, v131, v3
    v_mul_f32 v132, v132, v3
    v_mul_f32 v133, v133, v3
    v_mul_f32 v134, v134, v3
    v_mul_f32 v135, v135, v3
    v_mul_f32 v136, v136, v3
    v_mul_f32 v137, v137, v3
    v_mul_f32 v138, v138, v3
    v_mul_f32 v139, v139, v3
    v_mul_f32 v140, v140, v3
    v_mul_f32 v141, v141, v3
    v_mul_f32 v142, v142, v3
    v_mul_f32 v143, v143, v3
    v_mul_f32 v144, v144, v3
    v_mul_f32 v145, v145, v3
    v_mul_f32 v146, v146, v3
    v_mul_f32 v147, v147, v3
    v_mul_f32 v148, v148, v3
    v_mul_f32 v149, v149, v3
    v_mul_f32 v150, v150, v3
    v_mul_f32 v151, v151, v3
    v_mul_f32 v152, v152, v3
    v_mul_f32 v153, v153, v3
    v_mul_f32 v154, v154, v3
    v_mul_f32 v155, v155, v3
    v_mul_f32 v156, v156, v3
    v_mul_f32 v157, v157, v3
    v_mul_f32 v158, v158, v3
    v_mul_f32 v159, v159, v3
    v_mul_f32 v160, v160, v3
    v_mul_f32 v161, v161, v3
    v_mul_f32 v162, v162, v3
    v_mul_f32 v163, v163, v3
    v_mul_f32 v164, v164, v3
    v_mul_f32 v165, v165, v3
    v_mul_f32 v166, v166, v3
    v_mul_f32 v167, v167, v3
    v_mul_f32 v168, v168, v3
    v_mul_f32 v169, v169, v3
    v_mul_f32 v170, v170, v3
    v_mul_f32 v171, v171, v3
    v_mul_f32 v172, v172, v3
    v_mul_f32 v173, v173, v3
    v_mul_f32 v174, v174, v3
    v_mul_f32 v175, v175, v3
    s_nop 1
L_gqa_attn_kernel_skip4:
    ds_read_b64_tr_b16 v[214:215], v37 offset:26624
    v_fma_f32 v96, v96, s36, -v10
    v_fma_f32 v97, v97, s36, -v10
    v_fma_f32 v98, v98, s36, -v10
    v_fma_f32 v99, v99, s36, -v10
    v_mfma_f32_32x32x16_bf16 v[80:95], v[184:187], v[56:59], v[80:95]
    v_fma_f32 v100, v100, s36, -v10
    ds_read_b64_tr_b16 v[216:217], v38 offset:24576
    v_fma_f32 v101, v101, s36, -v10
    v_fma_f32 v102, v102, s36, -v10
    v_fma_f32 v103, v103, s36, -v10
    v_fma_f32 v104, v104, s36, -v10
    ds_read_b64_tr_b16 v[218:219], v38 offset:26624
    v_fma_f32 v105, v105, s36, -v10
    v_fma_f32 v106, v106, s36, -v10
    v_fma_f32 v107, v107, s36, -v10
    v_mfma_f32_32x32x16_bf16 v[80:95], v[188:191], v[60:63], v[80:95]
    v_fma_f32 v108, v108, s36, -v10
    ds_read_b64_tr_b16 v[220:221], v39 offset:24576
    v_fma_f32 v109, v109, s36, -v10
    v_fma_f32 v110, v110, s36, -v10
    v_fma_f32 v111, v111, s36, -v10
    v_exp_f32 v96, v96
    v_exp_f32 v97, v97
    ds_read_b64_tr_b16 v[222:223], v39 offset:26624
    v_exp_f32 v98, v98
    v_exp_f32 v99, v99
    v_exp_f32 v100, v100
    v_mfma_f32_32x32x16_bf16 v[80:95], v[192:195], v[64:67], v[80:95]
    v_exp_f32 v101, v101
    s_waitcnt lgkmcnt(7)
    ds_read_b64_tr_b16 v[224:225], v36 offset:28672
    v_exp_f32 v102, v102
    v_exp_f32 v103, v103
    v_exp_f32 v104, v104
    v_exp_f32 v105, v105
    ds_read_b64_tr_b16 v[226:227], v36 offset:30720
    v_exp_f32 v106, v106
    v_exp_f32 v107, v107
    v_exp_f32 v108, v108
    v_exp_f32 v109, v109
    v_mfma_f32_32x32x16_bf16 v[80:95], v[196:199], v[68:71], v[80:95]
    v_exp_f32 v110, v110
    ds_read_b64_tr_b16 v[228:229], v37 offset:28672
    v_exp_f32 v111, v111
    v_cvt_pk_bf16_f32 v40, v96, v97
    v_cvt_pk_bf16_f32 v41, v98, v99
    v_cvt_pk_bf16_f32 v42, v100, v101
    ds_read_b64_tr_b16 v[230:231], v37 offset:30720
    v_cvt_pk_bf16_f32 v43, v102, v103
    v_cvt_pk_bf16_f32 v44, v104, v105
    v_cvt_pk_bf16_f32 v45, v106, v107
    v_mfma_f32_32x32x16_bf16 v[80:95], v[200:203], v[72:75], v[80:95]
    v_cvt_pk_bf16_f32 v46, v108, v109
    ds_read_b64_tr_b16 v[232:233], v38 offset:28672
    v_cvt_pk_bf16_f32 v47, v110, v111
    v_add_f32 v1, v96, v97
    v_add_f32 v2, v98, v99
    v_add_f32 v3, v100, v101
    v_add_f32 v4, v102, v103
    ds_read_b64_tr_b16 v[234:235], v38 offset:30720
    v_add_f32 v1, v1, v104
    v_add_f32 v2, v2, v105
    v_add_f32 v3, v3, v106
    v_mfma_f32_32x32x16_bf16 v[80:95], v[204:207], v[76:79], v[80:95]
    v_add_f32 v4, v4, v107
    ds_read_b64_tr_b16 v[236:237], v39 offset:28672
    v_add_f32 v1, v1, v108
    v_add_f32 v2, v2, v109
    v_add_f32 v3, v3, v110
    v_add_f32 v4, v4, v111
    ds_read_b64_tr_b16 v[238:239], v39 offset:30720
    v_add_f32 v1, v1, v2
    v_add_f32 v3, v3, v4
    v_add_f32 v1, v1, v3
    v_add_f32 v12, v12, v1
    s_waitcnt lgkmcnt(0)
    ds_read_b128 v[176:179], v28 offset:8192
    ds_read_b128 v[180:183], v29 offset:8192
    v_mfma_f32_32x32x16_bf16 v[112:127], v[208:211], v[40:43], v[112:127]
    ds_read_b128 v[184:187], v30 offset:8192
    ds_read_b128 v[188:191], v31 offset:8192
    v_mfma_f32_32x32x16_bf16 v[128:143], v[212:215], v[40:43], v[128:143]
    ds_read_b128 v[192:195], v32 offset:8192
    ds_read_b128 v[196:199], v33 offset:8192
    v_mfma_f32_32x32x16_bf16 v[144:159], v[216:219], v[40:43], v[144:159]
    ds_read_b128 v[200:203], v34 offset:8192
    ds_read_b128 v[204:207], v35 offset:8192
    v_mfma_f32_32x32x16_bf16 v[160:175], v[220:223], v[40:43], v[160:175]
    v_mfma_f32_32x32x16_bf16 v[112:127], v[224:227], v[44:47], v[112:127]
    s_add_u32 m0, s31, 0
    s_nop 0
    buffer_load_dwordx4 v24, s[16:19], s32 offen nt lds
    v_mfma_f32_32x32x16_bf16 v[128:143], v[228:231], v[44:47], v[128:143]
    s_add_u32 m0, s31, 4096
    s_nop 0
    buffer_load_dwordx4 v25, s[16:19], s32 offen nt lds
    s_add_u32 s32, s32, 8192
    v_mfma_f32_32x32x16_bf16 v[144:159], v[232:235], v[44:47], v[144:159]
    s_add_u32 m0, s31, 49152
    s_nop 0
    buffer_load_dwordx4 v26, s[20:23], s33 offen nt lds
    v_mfma_f32_32x32x16_bf16 v[160:175], v[236:239], v[44:47], v[160:175]
    s_add_u32 m0, s31, 53248
    s_nop 0
    buffer_load_dwordx4 v27, s[20:23], s33 offen nt lds
    s_add_u32 s33, s33, 8192
    s_sub_u32 s38, s38, 1
    s_cmp_lg_u32 s38, 0
    s_cbranch_scc1 L_gqa_attn_kernel_loop
    s_waitcnt vmcnt(8) lgkmcnt(0)
    s_barrier
    v_mfma_f32_32x32x16_bf16 v[96:111], v[176:179], v[48:51], 0
    v_max3_f32 v1, v80, v81, v82
    ds_read_b64_tr_b16 v[208:209], v36 offset:0
    v_max3_f32 v2, v83, v84, v85
    v_max3_f32 v3, v86, v87, v88
    v_max3_f32 v4, v89, v90, v91
    v_max3_f32 v1, v1, v92, v93
    ds_read_b64_tr_b16 v[210:211], v36 offset:2048
    v_max3_f32 v2, v2, v94, v95
    v_max3_f32 v1, v1, v2, v3
    v_max_f32 v1, v1, v4
    v_mfma_f32_32x32x16_bf16 v[96:111], v[180:183], v[52:55], v[96:111]
    v_mov_b32 v2, v1
    s_nop 1
    v_permlane32_swap_b32 v1, v2
    ds_read_b64_tr_b16 v[212:213], v37 offset:0
    v_max_f32 v1, v1, v2
    v_mul_f32 v1, s36, v1
    v_sub_f32 v3, v1, v10
    v_cmp_lt_f32 vcc, s37, v3
    s_cbranch_vccz L_gqa_attn_kernel_skip25
    v_max_f32 v4, v10, v1
    v_sub_f32 v3, v10, v4
    v_exp_f32 v3, v3
    v_mov_b32 v10, v4
    s_nop 7
    v_mul_f32 v12, v12, v3
    v_mul_f32 v112, v112, v3
    v_mul_f32 v113, v113, v3
    v_mul_f32 v114, v114, v3
    v_mul_f32 v115, v115, v3
    v_mul_f32 v116, v116, v3
    v_mul_f32 v117, v117, v3
    v_mul_f32 v118, v118, v3
    v_mul_f32 v119, v119, v3
    v_mul_f32 v120, v120, v3
    v_mul_f32 v121, v121, v3
    v_mul_f32 v122, v122, v3
    v_mul_f32 v123, v123, v3
    v_mul_f32 v124, v124, v3
    v_mul_f32 v125, v125, v3
    v_mul_f32 v126, v126, v3
    v_mul_f32 v127, v127, v3
    v_mul_f32 v128, v128, v3
    v_mul_f32 v129, v129, v3
    v_mul_f32 v130, v130, v3
    v_mul_f32 v131, v131, v3
    v_mul_f32 v132, v132, v3
    v_mul_f32 v133, v133, v3
    v_mul_f32 v134, v134, v3
    v_mul_f32 v135, v135, v3
    v_mul_f32 v136, v136, v3
    v_mul_f32 v137, v137, v3
    v_mul_f32 v138, v138, v3
    v_mul_f32 v139, v139, v3
    v_mul_f32 v140, v140, v3
    v_mul_f32 v141, v141, v3
    v_mul_f32 v142, v142, v3
    v_mul_f32 v143, v143, v3
    v_mul_f32 v144, v144, v3
    v_mul_f32 v145, v145, v3
    v_mul_f32 v146, v146, v3
    v_mul_f32 v147, v147, v3
    v_mul_f32 v148, v148, v3
    v_mul_f32 v149, v149, v3
    v_mul_f32 v150, v150, v3
    v_mul_f32 v151, v151, v3
    v_mul_f32 v152, v152, v3
    v_mul_f32 v153, v153, v3
    v_mul_f32 v154, v154, v3
    v_mul_f32 v155, v155, v3
    v_mul_f32 v156, v156, v3
    v_mul_f32 v157, v157, v3
    v_mul_f32 v158, v158, v3
    v_mul_f32 v159, v159, v3
    v_mul_f32 v160, v160, v3
    v_mul_f32 v161, v161, v3
    v_mul_f32 v162, v162, v3
    v_mul_f32 v163, v163, v3
    v_mul_f32 v164, v164, v3
    v_mul_f32 v165, v165, v3
    v_mul_f32 v166, v166, v3
    v_mul_f32 v167, v167, v3
    v_mul_f32 v168, v168, v3
    v_mul_f32 v169, v169, v3
    v_mul_f32 v170, v170, v3
    v_mul_f32 v171, v171, v3
    v_mul_f32 v172, v172, v3
    v_mul_f32 v173, v173, v3
    v_mul_f32 v174, v174, v3
    v_mul_f32 v175, v175, v3
    s_nop 1
L_gqa_attn_kernel_skip25:
    ds_read_b64_tr_b16 v[214:215], v37 offset:2048
    v_fma_f32 v80, v80, s36, -v10
    v_fma_f32 v81, v81, s36, -v10
    v_fma_f32 v82, v82, s36, -v10
    v_fma_f32 v83, v83, s36, -v10
    v_mfma_f32_32x32x16_bf16 v[96:111], v[184:187], v[56:59], v[96:111]
    v_fma_f32 v84, v84, s36, -v10
    ds_read_b64_tr_b16 v[216:217], v38 offset:0
    v_fma_f32 v85, v85, s36, -v10
    v_fma_f32 v86, v86, s36, -v10
    v_fma_f32 v87, v87, s36, -v10
    v_fma_f32 v88, v88, s36, -v10
    ds_read_b64_tr_b16 v[218:219], v38 offset:2048
    v_fma_f32 v89, v89, s36, -v10
    v_fma_f32 v90, v90, s36, -v10
    v_fma_f32 v91, v91, s36, -v10
    v_mfma_f32_32x32x16_bf16 v[96:111], v[188:191], v[60:63], v[96:111]
    v_fma_f32 v92, v92, s36, -v10
    ds_read_b64_tr_b16 v[220:221], v39 offset:0
    v_fma_f32 v93, v93, s36, -v10
    v_fma_f32 v94, v94, s36, -v10
    v_fma_f32 v95, v95, s36, -v10
    v_exp_f32 v80, v80
    v_exp_f32 v81, v81
    ds_read_b64_tr_b16 v[222:223], v39 offset:2048
    v_exp_f32 v82, v82
    v_exp_f32 v83, v83
    v_exp_f32 v84, v84
    v_mfma_f32_32x32x16_bf16 v[96:111], v[192:195], v[64:67], v[96:111]
    v_exp_f32 v85, v85
    s_waitcnt lgkmcnt(7)
    ds_read_b64_tr_b16 v[224:225], v36 offset:4096
    v_exp_f32 v86, v86
    v_exp_f32 v87, v87
    v_exp_f32 v88, v88
    v_exp_f32 v89, v89
    ds_read_b64_tr_b16 v[226:227], v36 offset:6144
    v_exp_f32 v90, v90
    v_exp_f32 v91, v91
    v_exp_f32 v92, v92
    v_exp_f32 v93, v93
    v_mfma_f32_32x32x16_bf16 v[96:111], v[196:199], v[68:71], v[96:111]
    v_exp_f32 v94, v94
    ds_read_b64_tr_b16 v[228:229], v37 offset:4096
    v_exp_f32 v95, v95
    v_cvt_pk_bf16_f32 v40, v80, v81
    v_cvt_pk_bf16_f32 v41, v82, v83
    v_cvt_pk_bf16_f32 v42, v84, v85
    ds_read_b64_tr_b16 v[230:231], v37 offset:6144
    v_cvt_pk_bf16_f32 v43, v86, v87
    v_cvt_pk_bf16_f32 v44, v88, v89
    v_cvt_pk_bf16_f32 v45, v90, v91
    v_mfma_f32_32x32x16_bf16 v[96:111], v[200:203], v[72:75], v[96:111]
    v_cvt_pk_bf16_f32 v46, v92, v93
    ds_read_b64_tr_b16 v[232:233], v38 offset:4096
    v_cvt_pk_bf16_f32 v47, v94, v95
    v_add_f32 v1, v80, v81
    v_add_f32 v2, v82, v83
    v_add_f32 v3, v84, v85
    v_add_f32 v4, v86, v87
    ds_read_b64_tr_b16 v[234:235], v38 offset:6144
    v_add_f32 v1, v1, v88
    v_add_f32 v2, v2, v89
    v_add_f32 v3, v3, v90
    v_mfma_f32_32x32x16_bf16 v[96:111], v[204:207], v[76:79], v[96:111]
    v_add_f32 v4, v4, v91
    ds_read_b64_tr_b16 v[236:237], v39 offset:4096
    v_add_f32 v1, v1, v92
    v_add_f32 v2, v2, v93
    v_add_f32 v3, v3, v94
    v_add_f32 v4, v4, v95
    ds_read_b64_tr_b16 v[238:239], v39 offset:6144
    v_add_f32 v1, v1, v2
    v_add_f32 v3, v3, v4
    v_add_f32 v1, v1, v3
    v_add_f32 v12, v12, v1
    s_waitcnt lgkmcnt(0)
    ds_read_b128 v[176:179], v28 offset:16384
    ds_read_b128 v[180:183], v29 offset:16384
    v_mfma_f32_32x32x16_bf16 v[112:127], v[208:211], v[40:43], v[112:127]
    ds_read_b128 v[184:187], v30 offset:16384
    ds_read_b128 v[188:191], v31 offset:16384
    v_mfma_f32_32x32x16_bf16 v[128:143], v[212:215], v[40:43], v[128:143]
    ds_read_b128 v[192:195], v32 offset:16384
    ds_read_b128 v[196:199], v33 offset:16384
    v_mfma_f32_32x32x16_bf16 v[144:159], v[216:219], v[40:43], v[144:159]
    ds_read_b128 v[200:203], v34 offset:16384
    ds_read_b128 v[204:207], v35 offset:16384
    v_mfma_f32_32x32x16_bf16 v[160:175], v[220:223], v[40:43], v[160:175]
    v_mfma_f32_32x32x16_bf16 v[112:127], v[224:227], v[44:47], v[112:127]
    s_add_u32 m0, s31, 8192
    s_nop 0
    buffer_load_dwordx4 v24, s[16:19], s32 offen nt lds
    v_mfma_f32_32x32x16_bf16 v[128:143], v[228:231], v[44:47], v[128:143]
    s_add_u32 m0, s31, 12288
    s_nop 0
    buffer_load_dwordx4 v25, s[16:19], s32 offen nt lds
    s_add_u32 s32, s32, 8192
    v_mfma_f32_32x32x16_bf16 v[144:159], v[232:235], v[44:47], v[144:159]
    s_add_u32 m0, s31, 57344
    s_nop 0
    buffer_load_dwordx4 v26, s[20:23], s33 offen nt lds
    v_mfma_f32_32x32x16_bf16 v[160:175], v[236:239], v[44:47], v[160:175]
    s_add_u32 m0, s31, 61440
    s_nop 0
    buffer_load_dwordx4 v27, s[20:23], s33 offen nt lds
    s_add_u32 s33, s33, 8192
    s_waitcnt vmcnt(8) lgkmcnt(0)
    s_barrier
    v_mfma_f32_32x32x16_bf16 v[80:95], v[176:179], v[48:51], 0
    v_max3_f32 v1, v96, v97, v98
    ds_read_b64_tr_b16 v[208:209], v36 offset:8192
    v_max3_f32 v2, v99, v100, v101
    v_max3_f32 v3, v102, v103, v104
    v_max3_f32 v4, v105, v106, v107
    v_max3_f32 v1, v1, v108, v109
    ds_read_b64_tr_b16 v[210:211], v36 offset:10240
    v_max3_f32 v2, v2, v110, v111
    v_max3_f32 v1, v1, v2, v3
    v_max_f32 v1, v1, v4
    v_mfma_f32_32x32x16_bf16 v[80:95], v[180:183], v[52:55], v[80:95]
    v_mov_b32 v2, v1
    s_nop 1
    v_permlane32_swap_b32 v1, v2
    ds_read_b64_tr_b16 v[212:213], v37 offset:8192
    v_max_f32 v1, v1, v2
    v_mul_f32 v1, s36, v1
    v_sub_f32 v3, v1, v10
    v_cmp_lt_f32 vcc, s37, v3
    s_cbranch_vccz L_gqa_attn_kernel_skip26
    v_max_f32 v4, v10, v1
    v_sub_f32 v3, v10, v4
    v_exp_f32 v3, v3
    v_mov_b32 v10, v4
    s_nop 7
    v_mul_f32 v12, v12, v3
    v_mul_f32 v112, v112, v3
    v_mul_f32 v113, v113, v3
    v_mul_f32 v114, v114, v3
    v_mul_f32 v115, v115, v3
    v_mul_f32 v116, v116, v3
    v_mul_f32 v117, v117, v3
    v_mul_f32 v118, v118, v3
    v_mul_f32 v119, v119, v3
    v_mul_f32 v120, v120, v3
    v_mul_f32 v121, v121, v3
    v_mul_f32 v122, v122, v3
    v_mul_f32 v123, v123, v3
    v_mul_f32 v124, v124, v3
    v_mul_f32 v125, v125, v3
    v_mul_f32 v126, v126, v3
    v_mul_f32 v127, v127, v3
    v_mul_f32 v128, v128, v3
    v_mul_f32 v129, v129, v3
    v_mul_f32 v130, v130, v3
    v_mul_f32 v131, v131, v3
    v_mul_f32 v132, v132, v3
    v_mul_f32 v133, v133, v3
    v_mul_f32 v134, v134, v3
    v_mul_f32 v135, v135, v3
    v_mul_f32 v136, v136, v3
    v_mul_f32 v137, v137, v3
    v_mul_f32 v138, v138, v3
    v_mul_f32 v139, v139, v3
    v_mul_f32 v140, v140, v3
    v_mul_f32 v141, v141, v3
    v_mul_f32 v142, v142, v3
    v_mul_f32 v143, v143, v3
    v_mul_f32 v144, v144, v3
    v_mul_f32 v145, v145, v3
    v_mul_f32 v146, v146, v3
    v_mul_f32 v147, v147, v3
    v_mul_f32 v148, v148, v3
    v_mul_f32 v149, v149, v3
    v_mul_f32 v150, v150, v3
    v_mul_f32 v151, v151, v3
    v_mul_f32 v152, v152, v3
    v_mul_f32 v153, v153, v3
    v_mul_f32 v154, v154, v3
    v_mul_f32 v155, v155, v3
    v_mul_f32 v156, v156, v3
    v_mul_f32 v157, v157, v3
    v_mul_f32 v158, v158, v3
    v_mul_f32 v159, v159, v3
    v_mul_f32 v160, v160, v3
    v_mul_f32 v161, v161, v3
    v_mul_f32 v162, v162, v3
    v_mul_f32 v163, v163, v3
    v_mul_f32 v164, v164, v3
    v_mul_f32 v165, v165, v3
    v_mul_f32 v166, v166, v3
    v_mul_f32 v167, v167, v3
    v_mul_f32 v168, v168, v3
    v_mul_f32 v169, v169, v3
    v_mul_f32 v170, v170, v3
    v_mul_f32 v171, v171, v3
    v_mul_f32 v172, v172, v3
    v_mul_f32 v173, v173, v3
    v_mul_f32 v174, v174, v3
    v_mul_f32 v175, v175, v3
    s_nop 1
L_gqa_attn_kernel_skip26:
    ds_read_b64_tr_b16 v[214:215], v37 offset:10240
    v_fma_f32 v96, v96, s36, -v10
    v_fma_f32 v97, v97, s36, -v10
    v_fma_f32 v98, v98, s36, -v10
    v_fma_f32 v99, v99, s36, -v10
    v_mfma_f32_32x32x16_bf16 v[80:95], v[184:187], v[56:59], v[80:95]
    v_fma_f32 v100, v100, s36, -v10
    ds_read_b64_tr_b16 v[216:217], v38 offset:8192
    v_fma_f32 v101, v101, s36, -v10
    v_fma_f32 v102, v102, s36, -v10
    v_fma_f32 v103, v103, s36, -v10
    v_fma_f32 v104, v104, s36, -v10
    ds_read_b64_tr_b16 v[218:219], v38 offset:10240
    v_fma_f32 v105, v105, s36, -v10
    v_fma_f32 v106, v106, s36, -v10
    v_fma_f32 v107, v107, s36, -v10
    v_mfma_f32_32x32x16_bf16 v[80:95], v[188:191], v[60:63], v[80:95]
    v_fma_f32 v108, v108, s36, -v10
    ds_read_b64_tr_b16 v[220:221], v39 offset:8192
    v_fma_f32 v109, v109, s36, -v10
    v_fma_f32 v110, v110, s36, -v10
    v_fma_f32 v111, v111, s36, -v10
    v_exp_f32 v96, v96
    v_exp_f32 v97, v97
    ds_read_b64_tr_b16 v[222:223], v39 offset:10240
    v_exp_f32 v98, v98
    v_exp_f32 v99, v99
    v_exp_f32 v100, v100
    v_mfma_f32_32x32x16_bf16 v[80:95], v[192:195], v[64:67], v[80:95]
    v_exp_f32 v101, v101
    s_waitcnt lgkmcnt(7)
    ds_read_b64_tr_b16 v[224:225], v36 offset:12288
    v_exp_f32 v102, v102
    v_exp_f32 v103, v103
    v_exp_f32 v104, v104
    v_exp_f32 v105, v105
    ds_read_b64_tr_b16 v[226:227], v36 offset:14336
    v_exp_f32 v106, v106
    v_exp_f32 v107, v107
    v_exp_f32 v108, v108
    v_exp_f32 v109, v109
    v_mfma_f32_32x32x16_bf16 v[80:95], v[196:199], v[68:71], v[80:95]
    v_exp_f32 v110, v110
    ds_read_b64_tr_b16 v[228:229], v37 offset:12288
    v_exp_f32 v111, v111
    v_cvt_pk_bf16_f32 v40, v96, v97
    v_cvt_pk_bf16_f32 v41, v98, v99
    v_cvt_pk_bf16_f32 v42, v100, v101
    ds_read_b64_tr_b16 v[230:231], v37 offset:14336
    v_cvt_pk_bf16_f32 v43, v102, v103
    v_cvt_pk_bf16_f32 v44, v104, v105
    v_cvt_pk_bf16_f32 v45, v106, v107
    v_mfma_f32_32x32x16_bf16 v[80:95], v[200:203], v[72:75], v[80:95]
    v_cvt_pk_bf16_f32 v46, v108, v109
    ds_read_b64_tr_b16 v[232:233], v38 offset:12288
    v_cvt_pk_bf16_f32 v47, v110, v111
    v_add_f32 v1, v96, v97
    v_add_f32 v2, v98, v99
    v_add_f32 v3, v100, v101
    v_add_f32 v4, v102, v103
    ds_read_b64_tr_b16 v[234:235], v38 offset:14336
    v_add_f32 v1, v1, v104
    v_add_f32 v2, v2, v105
    v_add_f32 v3, v3, v106
    v_mfma_f32_32x32x16_bf16 v[80:95], v[204:207], v[76:79], v[80:95]
    v_add_f32 v4, v4, v107
    ds_read_b64_tr_b16 v[236:237], v39 offset:12288
    v_add_f32 v1, v1, v108
    v_add_f32 v2, v2, v109
    v_add_f32 v3, v3, v110
    v_add_f32 v4, v4, v111
    ds_read_b64_tr_b16 v[238:239], v39 offset:14336
    v_add_f32 v1, v1, v2
    v_add_f32 v3, v3, v4
    v_add_f32 v1, v1, v3
    v_add_f32 v12, v12, v1
    s_waitcnt lgkmcnt(0)
    ds_read_b128 v[176:179], v28 offset:24576
    ds_read_b128 v[180:183], v29 offset:24576
    v_mfma_f32_32x32x16_bf16 v[112:127], v[208:211], v[40:43], v[112:127]
    ds_read_b128 v[184:187], v30 offset:24576
    ds_read_b128 v[188:191], v31 offset:24576
    v_mfma_f32_32x32x16_bf16 v[128:143], v[212:215], v[40:43], v[128:143]
    ds_read_b128 v[192:195], v32 offset:24576
    ds_read_b128 v[196:199], v33 offset:24576
    v_mfma_f32_32x32x16_bf16 v[144:159], v[216:219], v[40:43], v[144:159]
    ds_read_b128 v[200:203], v34 offset:24576
    ds_read_b128 v[204:207], v35 offset:24576
    v_mfma_f32_32x32x16_bf16 v[160:175], v[220:223], v[40:43], v[160:175]
    v_mfma_f32_32x32x16_bf16 v[112:127], v[224:227], v[44:47], v[112:127]
    s_add_u32 m0, s31, 16384
    s_nop 0
    buffer_load_dwordx4 v24, s[16:19], s32 offen nt lds
    v_mfma_f32_32x32x16_bf16 v[128:143], v[228:231], v[44:47], v[128:143]
    s_add_u32 m0, s31, 20480
    s_nop 0
    buffer_load_dwordx4 v25, s[16:19], s32 offen nt lds
    s_add_u32 s32, s32, 8192
    v_mfma_f32_32x32x16_bf16 v[144:159], v[232:235], v[44:47], v[144:159]
    s_add_u32 m0, s31, 32768
    s_nop 0
    buffer_load_dwordx4 v26, s[20:23], s33 offen nt lds
    v_mfma_f32_32x32x16_bf16 v[160:175], v[236:239], v[44:47], v[160:175]
    s_add_u32 m0, s31, 36864
    s_nop 0
    buffer_load_dwordx4 v27, s[20:23], s33 offen nt lds
    s_add_u32 s33, s33, 8192
    s_waitcnt vmcnt(8) lgkmcnt(0)
    s_barrier
    v_mfma_f32_32x32x16_bf16 v[96:111], v[176:179], v[48:51], 0
    v_max3_f32 v1, v80, v81, v82
    ds_read_b64_tr_b16 v[208:209], v36 offset:16384
    v_max3_f32 v2, v83, v84, v85
    v_max3_f32 v3, v86, v87, v88
    v_max3_f32 v4, v89, v90, v91
    v_max3_f32 v1, v1, v92, v93
    ds_read_b64_tr_b16 v[210:211], v36 offset:18432
    v_max3_f32 v2, v2, v94, v95
    v_max3_f32 v1, v1, v2, v3
    v_max_f32 v1, v1, v4
    v_mfma_f32_32x32x16_bf16 v[96:111], v[180:183], v[52:55], v[96:111]
    v_mov_b32 v2, v1
    s_nop 1
    v_permlane32_swap_b32 v1, v2
    ds_read_b64_tr_b16 v[212:213], v37 offset:16384
    v_max_f32 v1, v1, v2
    v_mul_f32 v1, s36, v1
    v_sub_f32 v3, v1, v10
    v_cmp_lt_f32 vcc, s37, v3
    s_cbranch_vccz L_gqa_attn_kernel_skip27
    v_max_f32 v4, v10, v1
    v_sub_f32 v3, v10, v4
    v_exp_f32 v3, v3
    v_mov_b32 v10, v4
    s_nop 7
    v_mul_f32 v12, v12, v3
    v_mul_f32 v112, v112, v3
    v_mul_f32 v113, v113, v3
    v_mul_f32 v114, v114, v3
    v_mul_f32 v115, v115, v3
    v_mul_f32 v116, v116, v3
    v_mul_f32 v117, v117, v3
    v_mul_f32 v118, v118, v3
    v_mul_f32 v119, v119, v3
    v_mul_f32 v120, v120, v3
    v_mul_f32 v121, v121, v3
    v_mul_f32 v122, v122, v3
    v_mul_f32 v123, v123, v3
    v_mul_f32 v124, v124, v3
    v_mul_f32 v125, v125, v3
    v_mul_f32 v126, v126, v3
    v_mul_f32 v127, v127, v3
    v_mul_f32 v128, v128, v3
    v_mul_f32 v129, v129, v3
    v_mul_f32 v130, v130, v3
    v_mul_f32 v131, v131, v3
    v_mul_f32 v132, v132, v3
    v_mul_f32 v133, v133, v3
    v_mul_f32 v134, v134, v3
    v_mul_f32 v135, v135, v3
    v_mul_f32 v136, v136, v3
    v_mul_f32 v137, v137, v3
    v_mul_f32 v138, v138, v3
    v_mul_f32 v139, v139, v3
    v_mul_f32 v140, v140, v3
    v_mul_f32 v141, v141, v3
    v_mul_f32 v142, v142, v3
    v_mul_f32 v143, v143, v3
    v_mul_f32 v144, v144, v3
    v_mul_f32 v145, v145, v3
    v_mul_f32 v146, v146, v3
    v_mul_f32 v147, v147, v3
    v_mul_f32 v148, v148, v3
    v_mul_f32 v149, v149, v3
    v_mul_f32 v150, v150, v3
    v_mul_f32 v151, v151, v3
    v_mul_f32 v152, v152, v3
    v_mul_f32 v153, v153, v3
    v_mul_f32 v154, v154, v3
    v_mul_f32 v155, v155, v3
    v_mul_f32 v156, v156, v3
    v_mul_f32 v157, v157, v3
    v_mul_f32 v158, v158, v3
    v_mul_f32 v159, v159, v3
    v_mul_f32 v160, v160, v3
    v_mul_f32 v161, v161, v3
    v_mul_f32 v162, v162, v3
    v_mul_f32 v163, v163, v3
    v_mul_f32 v164, v164, v3
    v_mul_f32 v165, v165, v3
    v_mul_f32 v166, v166, v3
    v_mul_f32 v167, v167, v3
    v_mul_f32 v168, v168, v3
    v_mul_f32 v169, v169, v3
    v_mul_f32 v170, v170, v3
    v_mul_f32 v171, v171, v3
    v_mul_f32 v172, v172, v3
    v_mul_f32 v173, v173, v3
    v_mul_f32 v174, v174, v3
    v_mul_f32 v175, v175, v3
    s_nop 1
L_gqa_attn_kernel_skip27:
    ds_read_b64_tr_b16 v[214:215], v37 offset:18432
    v_fma_f32 v80, v80, s36, -v10
    v_fma_f32 v81, v81, s36, -v10
    v_fma_f32 v82, v82, s36, -v10
    v_fma_f32 v83, v83, s36, -v10
    v_mfma_f32_32x32x16_bf16 v[96:111], v[184:187], v[56:59], v[96:111]
    v_fma_f32 v84, v84, s36, -v10
    ds_read_b64_tr_b16 v[216:217], v38 offset:16384
    v_fma_f32 v85, v85, s36, -v10
    v_fma_f32 v86, v86, s36, -v10
    v_fma_f32 v87, v87, s36, -v10
    v_fma_f32 v88, v88, s36, -v10
    ds_read_b64_tr_b16 v[218:219], v38 offset:18432
    v_fma_f32 v89, v89, s36, -v10
    v_fma_f32 v90, v90, s36, -v10
    v_fma_f32 v91, v91, s36, -v10
    v_mfma_f32_32x32x16_bf16 v[96:111], v[188:191], v[60:63], v[96:111]
    v_fma_f32 v92, v92, s36, -v10
    ds_read_b64_tr_b16 v[220:221], v39 offset:16384
    v_fma_f32 v93, v93, s36, -v10
    v_fma_f32 v94, v94, s36, -v10
    v_fma_f32 v95, v95, s36, -v10
    v_exp_f32 v80, v80
    v_exp_f32 v81, v81
    ds_read_b64_tr_b16 v[222:223], v39 offset:18432
    v_exp_f32 v82, v82
    v_exp_f32 v83, v83
    v_exp_f32 v84, v84
    v_mfma_f32_32x32x16_bf16 v[96:111], v[192:195], v[64:67], v[96:111]
    v_exp_f32 v85, v85
    s_waitcnt lgkmcnt(7)
    ds_read_b64_tr_b16 v[224:225], v36 offset:20480
    v_exp_f32 v86, v86
    v_exp_f32 v87, v87
    v_exp_f32 v88, v88
    v_exp_f32 v89, v89
    ds_read_b64_tr_b16 v[226:227], v36 offset:22528
    v_exp_f32 v90, v90
    v_exp_f32 v91, v91
    v_exp_f32 v92, v92
    v_exp_f32 v93, v93
    v_mfma_f32_32x32x16_bf16 v[96:111], v[196:199], v[68:71], v[96:111]
    v_exp_f32 v94, v94
    ds_read_b64_tr_b16 v[228:229], v37 offset:20480
    v_exp_f32 v95, v95
    v_cvt_pk_bf16_f32 v40, v80, v81
    v_cvt_pk_bf16_f32 v41, v82, v83
    v_cvt_pk_bf16_f32 v42, v84, v85
    ds_read_b64_tr_b16 v[230:231], v37 offset:22528
    v_cvt_pk_bf16_f32 v43, v86, v87
    v_cvt_pk_bf16_f32 v44, v88, v89
    v_cvt_pk_bf16_f32 v45, v90, v91
    v_mfma_f32_32x32x16_bf16 v[96:111], v[200:203], v[72:75], v[96:111]
    v_cvt_pk_bf16_f32 v46, v92, v93
    ds_read_b64_tr_b16 v[232:233], v38 offset:20480
    v_cvt_pk_bf16_f32 v47, v94, v95
    v_add_f32 v1, v80, v81
    v_add_f32 v2, v82, v83
    v_add_f32 v3, v84, v85
    v_add_f32 v4, v86, v87
    ds_read_b64_tr_b16 v[234:235], v38 offset:22528
    v_add_f32 v1, v1, v88
    v_add_f32 v2, v2, v89
    v_add_f32 v3, v3, v90
    v_mfma_f32_32x32x16_bf16 v[96:111], v[204:207], v[76:79], v[96:111]
    v_add_f32 v4, v4, v91
    ds_read_b64_tr_b16 v[236:237], v39 offset:20480
    v_add_f32 v1, v1, v92
    v_add_f32 v2, v2, v93
    v_add_f32 v3, v3, v94
    v_add_f32 v4, v4, v95
    ds_read_b64_tr_b16 v[238:239], v39 offset:22528
    v_add_f32 v1, v1, v2
    v_add_f32 v3, v3, v4
    v_add_f32 v1, v1, v3
    v_add_f32 v12, v12, v1
    s_waitcnt lgkmcnt(0)
    ds_read_b128 v[176:179], v28 offset:0
    ds_read_b128 v[180:183], v29 offset:0
    v_mfma_f32_32x32x16_bf16 v[112:127], v[208:211], v[40:43], v[112:127]
    ds_read_b128 v[184:187], v30 offset:0
    ds_read_b128 v[188:191], v31 offset:0
    v_mfma_f32_32x32x16_bf16 v[128:143], v[212:215], v[40:43], v[128:143]
    ds_read_b128 v[192:195], v32 offset:0
    ds_read_b128 v[196:199], v33 offset:0
    v_mfma_f32_32x32x16_bf16 v[144:159], v[216:219], v[40:43], v[144:159]
    ds_read_b128 v[200:203], v34 offset:0
    ds_read_b128 v[204:207], v35 offset:0
    v_mfma_f32_32x32x16_bf16 v[160:175], v[220:223], v[40:43], v[160:175]
    v_mfma_f32_32x32x16_bf16 v[112:127], v[224:227], v[44:47], v[112:127]
    s_add_u32 m0, s31, 24576
    s_nop 0
    buffer_load_dwordx4 v24, s[16:19], s32 offen nt lds
    v_mfma_f32_32x32x16_bf16 v[128:143], v[228:231], v[44:47], v[128:143]
    s_add_u32 m0, s31, 28672
    s_nop 0
    buffer_load_dwordx4 v25, s[16:19], s32 offen nt lds
    s_add_u32 s32, s32, 8192
    v_mfma_f32_32x32x16_bf16 v[144:159], v[232:235], v[44:47], v[144:159]
    s_add_u32 m0, s31, 40960
    s_nop 0
    buffer_load_dwordx4 v26, s[20:23], s33 offen nt lds
    v_mfma_f32_32x32x16_bf16 v[160:175], v[236:239], v[44:47], v[160:175]
    s_add_u32 m0, s31, 45056
    s_nop 0
    buffer_load_dwordx4 v27, s[20:23], s33 offen nt lds
    s_add_u32 s33, s33, 8192
    s_waitcnt vmcnt(8) lgkmcnt(0)
    s_barrier
    v_mfma_f32_32x32x16_bf16 v[80:95], v[176:179], v[48:51], 0
    v_max3_f32 v1, v96, v97, v98
    ds_read_b64_tr_b16 v[208:209], v36 offset:24576
    v_max3_f32 v2, v99, v100, v101
    v_max3_f32 v3, v102, v103, v104
    v_max3_f32 v4, v105, v106, v107
    v_max3_f32 v1, v1, v108, v109
    ds_read_b64_tr_b16 v[210:211], v36 offset:26624
    v_max3_f32 v2, v2, v110, v111
    v_max3_f32 v1, v1, v2, v3
    v_max_f32 v1, v1, v4
    v_mfma_f32_32x32x16_bf16 v[80:95], v[180:183], v[52:55], v[80:95]
    v_mov_b32 v2, v1
    s_nop 1
    v_permlane32_swap_b32 v1, v2
    ds_read_b64_tr_b16 v[212:213], v37 offset:24576
    v_max_f32 v1, v1, v2
    v_mul_f32 v1, s36, v1
    v_sub_f32 v3, v1, v10
    v_cmp_lt_f32 vcc, s37, v3
    s_cbranch_vccz L_gqa_attn_kernel_skip28
    v_max_f32 v4, v10, v1
    v_sub_f32 v3, v10, v4
    v_exp_f32 v3, v3
    v_mov_b32 v10, v4
    s_nop 7
    v_mul_f32 v12, v12, v3
    v_mul_f32 v112, v112, v3
    v_mul_f32 v113, v113, v3
    v_mul_f32 v114, v114, v3
    v_mul_f32 v115, v115, v3
    v_mul_f32 v116, v116, v3
    v_mul_f32 v117, v117, v3
    v_mul_f32 v118, v118, v3
    v_mul_f32 v119, v119, v3
    v_mul_f32 v120, v120, v3
    v_mul_f32 v121, v121, v3
    v_mul_f32 v122, v122, v3
    v_mul_f32 v123, v123, v3
    v_mul_f32 v124, v124, v3
    v_mul_f32 v125, v125, v3
    v_mul_f32 v126, v126, v3
    v_mul_f32 v127, v127, v3
    v_mul_f32 v128, v128, v3
    v_mul_f32 v129, v129, v3
    v_mul_f32 v130, v130, v3
    v_mul_f32 v131, v131, v3
    v_mul_f32 v132, v132, v3
    v_mul_f32 v133, v133, v3
    v_mul_f32 v134, v134, v3
    v_mul_f32 v135, v135, v3
    v_mul_f32 v136, v136, v3
    v_mul_f32 v137, v137, v3
    v_mul_f32 v138, v138, v3
    v_mul_f32 v139, v139, v3
    v_mul_f32 v140, v140, v3
    v_mul_f32 v141, v141, v3
    v_mul_f32 v142, v142, v3
    v_mul_f32 v143, v143, v3
    v_mul_f32 v144, v144, v3
    v_mul_f32 v145, v145, v3
    v_mul_f32 v146, v146, v3
    v_mul_f32 v147, v147, v3
    v_mul_f32 v148, v148, v3
    v_mul_f32 v149, v149, v3
    v_mul_f32 v150, v150, v3
    v_mul_f32 v151, v151, v3
    v_mul_f32 v152, v152, v3
    v_mul_f32 v153, v153, v3
    v_mul_f32 v154, v154, v3
    v_mul_f32 v155, v155, v3
    v_mul_f32 v156, v156, v3
    v_mul_f32 v157, v157, v3
    v_mul_f32 v158, v158, v3
    v_mul_f32 v159, v159, v3
    v_mul_f32 v160, v160, v3
    v_mul_f32 v161, v161, v3
    v_mul_f32 v162, v162, v3
    v_mul_f32 v163, v163, v3
    v_mul_f32 v164, v164, v3
    v_mul_f32 v165, v165, v3
    v_mul_f32 v166, v166, v3
    v_mul_f32 v167, v167, v3
    v_mul_f32 v168, v168, v3
    v_mul_f32 v169, v169, v3
    v_mul_f32 v170, v170, v3
    v_mul_f32 v171, v171, v3
    v_mul_f32 v172, v172, v3
    v_mul_f32 v173, v173, v3
    v_mul_f32 v174, v174, v3
    v_mul_f32 v175, v175, v3
    s_nop 1
L_gqa_attn_kernel_skip28:
    ds_read_b64_tr_b16 v[214:215], v37 offset:26624
    v_fma_f32 v96, v96, s36, -v10
    v_fma_f32 v97, v97, s36, -v10
    v_fma_f32 v98, v98, s36, -v10
    v_fma_f32 v99, v99, s36, -v10
    v_mfma_f32_32x32x16_bf16 v[80:95], v[184:187], v[56:59], v[80:95]
    v_fma_f32 v100, v100, s36, -v10
    ds_read_b64_tr_b16 v[216:217], v38 offset:24576
    v_fma_f32 v101, v101, s36, -v10
    v_fma_f32 v102, v102, s36, -v10
    v_fma_f32 v103, v103, s36, -v10
    v_fma_f32 v104, v104, s36, -v10
    ds_read_b64_tr_b16 v[218:219], v38 offset:26624
    v_fma_f32 v105, v105, s36, -v10
    v_fma_f32 v106, v106, s36, -v10
    v_fma_f32 v107, v107, s36, -v10
    v_mfma_f32_32x32x16_bf16 v[80:95], v[188:191], v[60:63], v[80:95]
    v_fma_f32 v108, v108, s36, -v10
    ds_read_b64_tr_b16 v[220:221], v39 offset:24576
    v_fma_f32 v109, v109, s36, -v10
    v_fma_f32 v110, v110, s36, -v10
    v_fma_f32 v111, v111, s36, -v10
    v_exp_f32 v96, v96
    v_exp_f32 v97, v97
    ds_read_b64_tr_b16 v[222:223], v39 offset:26624
    v_exp_f32 v98, v98
    v_exp_f32 v99, v99
    v_exp_f32 v100, v100
    v_mfma_f32_32x32x16_bf16 v[80:95], v[192:195], v[64:67], v[80:95]
    v_exp_f32 v101, v101
    s_waitcnt lgkmcnt(7)
    ds_read_b64_tr_b16 v[224:225], v36 offset:28672
    v_exp_f32 v102, v102
    v_exp_f32 v103, v103
    v_exp_f32 v104, v104
    v_exp_f32 v105, v105
    ds_read_b64_tr_b16 v[226:227], v36 offset:30720
    v_exp_f32 v106, v106
    v_exp_f32 v107, v107
    v_exp_f32 v108, v108
    v_exp_f32 v109, v109
    v_mfma_f32_32x32x16_bf16 v[80:95], v[196:199], v[68:71], v[80:95]
    v_exp_f32 v110, v110
    ds_read_b64_tr_b16 v[228:229], v37 offset:28672
    v_exp_f32 v111, v111
    v_cvt_pk_bf16_f32 v40, v96, v97
    v_cvt_pk_bf16_f32 v41, v98, v99
    v_cvt_pk_bf16_f32 v42, v100, v101
    ds_read_b64_tr_b16 v[230:231], v37 offset:30720
    v_cvt_pk_bf16_f32 v43, v102, v103
    v_cvt_pk_bf16_f32 v44, v104, v105
    v_cvt_pk_bf16_f32 v45, v106, v107
    v_mfma_f32_32x32x16_bf16 v[80:95], v[200:203], v[72:75], v[80:95]
    v_cvt_pk_bf16_f32 v46, v108, v109
    ds_read_b64_tr_b16 v[232:233], v38 offset:28672
    v_cvt_pk_bf16_f32 v47, v110, v111
    v_add_f32 v1, v96, v97
    v_add_f32 v2, v98, v99
    v_add_f32 v3, v100, v101
    v_add_f32 v4, v102, v103
    ds_read_b64_tr_b16 v[234:235], v38 offset:30720
    v_add_f32 v1, v1, v104
    v_add_f32 v2, v2, v105
    v_add_f32 v3, v3, v106
    v_mfma_f32_32x32x16_bf16 v[80:95], v[204:207], v[76:79], v[80:95]
    v_add_f32 v4, v4, v107
    ds_read_b64_tr_b16 v[236:237], v39 offset:28672
    v_add_f32 v1, v1, v108
    v_add_f32 v2, v2, v109
    v_add_f32 v3, v3, v110
    v_add_f32 v4, v4, v111
    ds_read_b64_tr_b16 v[238:239], v39 offset:30720
    v_add_f32 v1, v1, v2
    v_add_f32 v3, v3, v4
    v_add_f32 v1, v1, v3
    v_add_f32 v12, v12, v1
    s_waitcnt lgkmcnt(0)
    ds_read_b128 v[176:179], v28 offset:8192
    ds_read_b128 v[180:183], v29 offset:8192
    v_mfma_f32_32x32x16_bf16 v[112:127], v[208:211], v[40:43], v[112:127]
    ds_read_b128 v[184:187], v30 offset:8192
    ds_read_b128 v[188:191], v31 offset:8192
    v_mfma_f32_32x32x16_bf16 v[128:143], v[212:215], v[40:43], v[128:143]
    ds_read_b128 v[192:195], v32 offset:8192
    ds_read_b128 v[196:199], v33 offset:8192
    v_mfma_f32_32x32x16_bf16 v[144:159], v[216:219], v[40:43], v[144:159]
    ds_read_b128 v[200:203], v34 offset:8192
    ds_read_b128 v[204:207], v35 offset:8192
    v_mfma_f32_32x32x16_bf16 v[160:175], v[220:223], v[40:43], v[160:175]
    v_mfma_f32_32x32x16_bf16 v[112:127], v[224:227], v[44:47], v[112:127]
    s_add_u32 m0, s31, 49152
    s_nop 0
    buffer_load_dwordx4 v26, s[20:23], s33 offen nt lds
    v_mfma_f32_32x32x16_bf16 v[128:143], v[228:231], v[44:47], v[128:143]
    s_add_u32 m0, s31, 53248
    s_nop 0
    buffer_load_dwordx4 v27, s[20:23], s33 offen nt lds
    s_add_u32 s33, s33, 8192
    v_mfma_f32_32x32x16_bf16 v[144:159], v[232:235], v[44:47], v[144:159]
    v_mfma_f32_32x32x16_bf16 v[160:175], v[236:239], v[44:47], v[160:175]
    s_waitcnt vmcnt(6) lgkmcnt(0)
    s_barrier
    v_mfma_f32_32x32x16_bf16 v[96:111], v[176:179], v[48:51], 0
    v_max3_f32 v1, v80, v81, v82
    ds_read_b64_tr_b16 v[208:209], v36 offset:0
    v_max3_f32 v2, v83, v84, v85
    v_max3_f32 v3, v86, v87, v88
    v_max3_f32 v4, v89, v90, v91
    v_max3_f32 v1, v1, v92, v93
    ds_read_b64_tr_b16 v[210:211], v36 offset:2048
    v_max3_f32 v2, v2, v94, v95
    v_max3_f32 v1, v1, v2, v3
    v_max_f32 v1, v1, v4
    v_mfma_f32_32x32x16_bf16 v[96:111], v[180:183], v[52:55], v[96:111]
    v_mov_b32 v2, v1
    s_nop 1
    v_permlane32_swap_b32 v1, v2
    ds_read_b64_tr_b16 v[212:213], v37 offset:0
    v_max_f32 v1, v1, v2
    v_mul_f32 v1, s36, v1
    v_sub_f32 v3, v1, v10
    v_cmp_lt_f32 vcc, s37, v3
    s_cbranch_vccz L_gqa_attn_kernel_skip29
    v_max_f32 v4, v10, v1
    v_sub_f32 v3, v10, v4
    v_exp_f32 v3, v3
    v_mov_b32 v10, v4
    s_nop 7
    v_mul_f32 v12, v12, v3
    v_mul_f32 v112, v112, v3
    v_mul_f32 v113, v113, v3
    v_mul_f32 v114, v114, v3
    v_mul_f32 v115, v115, v3
    v_mul_f32 v116, v116, v3
    v_mul_f32 v117, v117, v3
    v_mul_f32 v118, v118, v3
    v_mul_f32 v119, v119, v3
    v_mul_f32 v120, v120, v3
    v_mul_f32 v121, v121, v3
    v_mul_f32 v122, v122, v3
    v_mul_f32 v123, v123, v3
    v_mul_f32 v124, v124, v3
    v_mul_f32 v125, v125, v3
    v_mul_f32 v126, v126, v3
    v_mul_f32 v127, v127, v3
    v_mul_f32 v128, v128, v3
    v_mul_f32 v129, v129, v3
    v_mul_f32 v130, v130, v3
    v_mul_f32 v131, v131, v3
    v_mul_f32 v132, v132, v3
    v_mul_f32 v133, v133, v3
    v_mul_f32 v134, v134, v3
    v_mul_f32 v135, v135, v3
    v_mul_f32 v136, v136, v3
    v_mul_f32 v137, v137, v3
    v_mul_f32 v138, v138, v3
    v_mul_f32 v139, v139, v3
    v_mul_f32 v140, v140, v3
    v_mul_f32 v141, v141, v3
    v_mul_f32 v142, v142, v3
    v_mul_f32 v143, v143, v3
    v_mul_f32 v144, v144, v3
    v_mul_f32 v145, v145, v3
    v_mul_f32 v146, v146, v3
    v_mul_f32 v147, v147, v3
    v_mul_f32 v148, v148, v3
    v_mul_f32 v149, v149, v3
    v_mul_f32 v150, v150, v3
    v_mul_f32 v151, v151, v3
    v_mul_f32 v152, v152, v3
    v_mul_f32 v153, v153, v3
    v_mul_f32 v154, v154, v3
    v_mul_f32 v155, v155, v3
    v_mul_f32 v156, v156, v3
    v_mul_f32 v157, v157, v3
    v_mul_f32 v158, v158, v3
    v_mul_f32 v159, v159, v3
    v_mul_f32 v160, v160, v3
    v_mul_f32 v161, v161, v3
    v_mul_f32 v162, v162, v3
    v_mul_f32 v163, v163, v3
    v_mul_f32 v164, v164, v3
    v_mul_f32 v165, v165, v3
    v_mul_f32 v166, v166, v3
    v_mul_f32 v167, v167, v3
    v_mul_f32 v168, v168, v3
    v_mul_f32 v169, v169, v3
    v_mul_f32 v170, v170, v3
    v_mul_f32 v171, v171, v3
    v_mul_f32 v172, v172, v3
    v_mul_f32 v173, v173, v3
    v_mul_f32 v174, v174, v3
    v_mul_f32 v175, v175, v3
    s_nop 1
L_gqa_attn_kernel_skip29:
    ds_read_b64_tr_b16 v[214:215], v37 offset:2048
    v_fma_f32 v80, v80, s36, -v10
    v_fma_f32 v81, v81, s36, -v10
    v_fma_f32 v82, v82, s36, -v10
    v_fma_f32 v83, v83, s36, -v10
    v_mfma_f32_32x32x16_bf16 v[96:111], v[184:187], v[56:59], v[96:111]
    v_fma_f32 v84, v84, s36, -v10
    ds_read_b64_tr_b16 v[216:217], v38 offset:0
    v_fma_f32 v85, v85, s36, -v10
    v_fma_f32 v86, v86, s36, -v10
    v_fma_f32 v87, v87, s36, -v10
    v_fma_f32 v88, v88, s36, -v10
    ds_read_b64_tr_b16 v[218:219], v38 offset:2048
    v_fma_f32 v89, v89, s36, -v10
    v_fma_f32 v90, v90, s36, -v10
    v_fma_f32 v91, v91, s36, -v10
    v_mfma_f32_32x32x16_bf16 v[96:111], v[188:191], v[60:63], v[96:111]
    v_fma_f32 v92, v92, s36, -v10
    ds_read_b64_tr_b16 v[220:221], v39 offset:0
    v_fma_f32 v93, v93, s36, -v10
    v_fma_f32 v94, v94, s36, -v10
    v_fma_f32 v95, v95, s36, -v10
    v_exp_f32 v80, v80
    v_exp_f32 v81, v81
    ds_read_b64_tr_b16 v[222:223], v39 offset:2048
    v_exp_f32 v82, v82
    v_exp_f32 v83, v83
    v_exp_f32 v84, v84
    v_mfma_f32_32x32x16_bf16 v[96:111], v[192:195], v[64:67], v[96:111]
    v_exp_f32 v85, v85
    s_waitcnt lgkmcnt(7)
    ds_read_b64_tr_b16 v[224:225], v36 offset:4096
    v_exp_f32 v86, v86
    v_exp_f32 v87, v87
    v_exp_f32 v88, v88
    v_exp_f32 v89, v89
    ds_read_b64_tr_b16 v[226:227], v36 offset:6144
    v_exp_f32 v90, v90
    v_exp_f32 v91, v91
    v_exp_f32 v92, v92
    v_exp_f32 v93, v93
    v_mfma_f32_32x32x16_bf16 v[96:111], v[196:199], v[68:71], v[96:111]
    v_exp_f32 v94, v94
    ds_read_b64_tr_b16 v[228:229], v37 offset:4096
    v_exp_f32 v95, v95
    v_cvt_pk_bf16_f32 v40, v80, v81
    v_cvt_pk_bf16_f32 v41, v82, v83
    v_cvt_pk_bf16_f32 v42, v84, v85
    ds_read_b64_tr_b16 v[230:231], v37 offset:6144
    v_cvt_pk_bf16_f32 v43, v86, v87
    v_cvt_pk_bf16_f32 v44, v88, v89
    v_cvt_pk_bf16_f32 v45, v90, v91
    v_mfma_f32_32x32x16_bf16 v[96:111], v[200:203], v[72:75], v[96:111]
    v_cvt_pk_bf16_f32 v46, v92, v93
    ds_read_b64_tr_b16 v[232:233], v38 offset:4096
    v_cvt_pk_bf16_f32 v47, v94, v95
    v_add_f32 v1, v80, v81
    v_add_f32 v2, v82, v83
    v_add_f32 v3, v84, v85
    v_add_f32 v4, v86, v87
    ds_read_b64_tr_b16 v[234:235], v38 offset:6144
    v_add_f32 v1, v1, v88
    v_add_f32 v2, v2, v89
    v_add_f32 v3, v3, v90
    v_mfma_f32_32x32x16_bf16 v[96:111], v[204:207], v[76:79], v[96:111]
    v_add_f32 v4, v4, v91
    ds_read_b64_tr_b16 v[236:237], v39 offset:4096
    v_add_f32 v1, v1, v92
    v_add_f32 v2, v2, v93
    v_add_f32 v3, v3, v94
    v_add_f32 v4, v4, v95
    ds_read_b64_tr_b16 v[238:239], v39 offset:6144
    v_add_f32 v1, v1, v2
    v_add_f32 v3, v3, v4
    v_add_f32 v1, v1, v3
    v_add_f32 v12, v12, v1
    s_waitcnt lgkmcnt(0)
    ds_read_b128 v[176:179], v28 offset:16384
    ds_read_b128 v[180:183], v29 offset:16384
    v_mfma_f32_32x32x16_bf16 v[112:127], v[208:211], v[40:43], v[112:127]
    ds_read_b128 v[184:187], v30 offset:16384
    ds_read_b128 v[188:191], v31 offset:16384
    v_mfma_f32_32x32x16_bf16 v[128:143], v[212:215], v[40:43], v[128:143]
    ds_read_b128 v[192:195], v32 offset:16384
    ds_read_b128 v[196:199], v33 offset:16384
    v_mfma_f32_32x32x16_bf16 v[144:159], v[216:219], v[40:43], v[144:159]
    ds_read_b128 v[200:203], v34 offset:16384
    ds_read_b128 v[204:207], v35 offset:16384
    v_mfma_f32_32x32x16_bf16 v[160:175], v[220:223], v[40:43], v[160:175]
    v_mfma_f32_32x32x16_bf16 v[112:127], v[224:227], v[44:47], v[112:127]
    s_add_u32 m0, s31, 57344
    s_nop 0
    buffer_load_dwordx4 v26, s[20:23], s33 offen nt lds
    v_mfma_f32_32x32x16_bf16 v[128:143], v[228:231], v[44:47], v[128:143]
    s_add_u32 m0, s31, 61440
    s_nop 0
    buffer_load_dwordx4 v27, s[20:23], s33 offen nt lds
    s_add_u32 s33, s33, 8192
    v_mfma_f32_32x32x16_bf16 v[144:159], v[232:235], v[44:47], v[144:159]
    v_mfma_f32_32x32x16_bf16 v[160:175], v[236:239], v[44:47], v[160:175]
    s_waitcnt vmcnt(4) lgkmcnt(0)
    s_barrier
    v_mfma_f32_32x32x16_bf16 v[80:95], v[176:179], v[48:51], 0
    v_max3_f32 v1, v96, v97, v98
    ds_read_b64_tr_b16 v[208:209], v36 offset:8192
    v_max3_f32 v2, v99, v100, v101
    v_max3_f32 v3, v102, v103, v104
    v_max3_f32 v4, v105, v106, v107
    v_max3_f32 v1, v1, v108, v109
    ds_read_b64_tr_b16 v[210:211], v36 offset:10240
    v_max3_f32 v2, v2, v110, v111
    v_max3_f32 v1, v1, v2, v3
    v_max_f32 v1, v1, v4
    v_mfma_f32_32x32x16_bf16 v[80:95], v[180:183], v[52:55], v[80:95]
    v_mov_b32 v2, v1
    s_nop 1
    v_permlane32_swap_b32 v1, v2
    ds_read_b64_tr_b16 v[212:213], v37 offset:8192
    v_max_f32 v1, v1, v2
    v_mul_f32 v1, s36, v1
    v_sub_f32 v3, v1, v10
    v_cmp_lt_f32 vcc, s37, v3
    s_cbranch_vccz L_gqa_attn_kernel_skip30
    v_max_f32 v4, v10, v1
    v_sub_f32 v3, v10, v4
    v_exp_f32 v3, v3
    v_mov_b32 v10, v4
    s_nop 7
    v_mul_f32 v12, v12, v3
    v_mul_f32 v112, v112, v3
    v_mul_f32 v113, v113, v3
    v_mul_f32 v114, v114, v3
    v_mul_f32 v115, v115, v3
    v_mul_f32 v116, v116, v3
    v_mul_f32 v117, v117, v3
    v_mul_f32 v118, v118, v3
    v_mul_f32 v119, v119, v3
    v_mul_f32 v120, v120, v3
    v_mul_f32 v121, v121, v3
    v_mul_f32 v122, v122, v3
    v_mul_f32 v123, v123, v3
    v_mul_f32 v124, v124, v3
    v_mul_f32 v125, v125, v3
    v_mul_f32 v126, v126, v3
    v_mul_f32 v127, v127, v3
    v_mul_f32 v128, v128, v3
    v_mul_f32 v129, v129, v3
    v_mul_f32 v130, v130, v3
    v_mul_f32 v131, v131, v3
    v_mul_f32 v132, v132, v3
    v_mul_f32 v133, v133, v3
    v_mul_f32 v134, v134, v3
    v_mul_f32 v135, v135, v3
    v_mul_f32 v136, v136, v3
    v_mul_f32 v137, v137, v3
    v_mul_f32 v138, v138, v3
    v_mul_f32 v139, v139, v3
    v_mul_f32 v140, v140, v3
    v_mul_f32 v141, v141, v3
    v_mul_f32 v142, v142, v3
    v_mul_f32 v143, v143, v3
    v_mul_f32 v144, v144, v3
    v_mul_f32 v145, v145, v3
    v_mul_f32 v146, v146, v3
    v_mul_f32 v147, v147, v3
    v_mul_f32 v148, v148, v3
    v_mul_f32 v149, v149, v3
    v_mul_f32 v150, v150, v3
    v_mul_f32 v151, v151, v3
    v_mul_f32 v152, v152, v3
    v_mul_f32 v153, v153, v3
    v_mul_f32 v154, v154, v3
    v_mul_f32 v155, v155, v3
    v_mul_f32 v156, v156, v3
    v_mul_f32 v157, v157, v3
    v_mul_f32 v158, v158, v3
    v_mul_f32 v159, v159, v3
    v_mul_f32 v160, v160, v3
    v_mul_f32 v161, v161, v3
    v_mul_f32 v162, v162, v3
    v_mul_f32 v163, v163, v3
    v_mul_f32 v164, v164, v3
    v_mul_f32 v165, v165, v3
    v_mul_f32 v166, v166, v3
    v_mul_f32 v167, v167, v3
    v_mul_f32 v168, v168, v3
    v_mul_f32 v169, v169, v3
    v_mul_f32 v170, v170, v3
    v_mul_f32 v171, v171, v3
    v_mul_f32 v172, v172, v3
    v_mul_f32 v173, v173, v3
    v_mul_f32 v174, v174, v3
    v_mul_f32 v175, v175, v3
    s_nop 1
L_gqa_attn_kernel_skip30:
    ds_read_b64_tr_b16 v[214:215], v37 offset:10240
    v_fma_f32 v96, v96, s36, -v10
    v_fma_f32 v97, v97, s36, -v10
    v_fma_f32 v98, v98, s36, -v10
    v_fma_f32 v99, v99, s36, -v10
    v_mfma_f32_32x32x16_bf16 v[80:95], v[184:187], v[56:59], v[80:95]
    v_fma_f32 v100, v100, s36, -v10
    ds_read_b64_tr_b16 v[216:217], v38 offset:8192
    v_fma_f32 v101, v101, s36, -v10
    v_fma_f32 v102, v102, s36, -v10
    v_fma_f32 v103, v103, s36, -v10
    v_fma_f32 v104, v104, s36, -v10
    ds_read_b64_tr_b16 v[218:219], v38 offset:10240
    v_fma_f32 v105, v105, s36, -v10
    v_fma_f32 v106, v106, s36, -v10
    v_fma_f32 v107, v107, s36, -v10
    v_mfma_f32_32x32x16_bf16 v[80:95], v[188:191], v[60:63], v[80:95]
    v_fma_f32 v108, v108, s36, -v10
    ds_read_b64_tr_b16 v[220:221], v39 offset:8192
    v_fma_f32 v109, v109, s36, -v10
    v_fma_f32 v110, v110, s36, -v10
    v_fma_f32 v111, v111, s36, -v10
    v_exp_f32 v96, v96
    v_exp_f32 v97, v97
    ds_read_b64_tr_b16 v[222:223], v39 offset:10240
    v_exp_f32 v98, v98
    v_exp_f32 v99, v99
    v_exp_f32 v100, v100
    v_mfma_f32_32x32x16_bf16 v[80:95], v[192:195], v[64:67], v[80:95]
    v_exp_f32 v101, v101
    s_waitcnt lgkmcnt(7)
    ds_read_b64_tr_b16 v[224:225], v36 offset:12288
    v_exp_f32 v102, v102
    v_exp_f32 v103, v103
    v_exp_f32 v104, v104
    v_exp_f32 v105, v105
    ds_read_b64_tr_b16 v[226:227], v36 offset:14336
    v_exp_f32 v106, v106
    v_exp_f32 v107, v107
    v_exp_f32 v108, v108
    v_exp_f32 v109, v109
    v_mfma_f32_32x32x16_bf16 v[80:95], v[196:199], v[68:71], v[80:95]
    v_exp_f32 v110, v110
    ds_read_b64_tr_b16 v[228:229], v37 offset:12288
    v_exp_f32 v111, v111
    v_cvt_pk_bf16_f32 v40, v96, v97
    v_cvt_pk_bf16_f32 v41, v98, v99
    v_cvt_pk_bf16_f32 v42, v100, v101
    ds_read_b64_tr_b16 v[230:231], v37 offset:14336
    v_cvt_pk_bf16_f32 v43, v102, v103
    v_cvt_pk_bf16_f32 v44, v104, v105
    v_cvt_pk_bf16_f32 v45, v106, v107
    v_mfma_f32_32x32x16_bf16 v[80:95], v[200:203], v[72:75], v[80:95]
    v_cvt_pk_bf16_f32 v46, v108, v109
    ds_read_b64_tr_b16 v[232:233], v38 offset:12288
    v_cvt_pk_bf16_f32 v47, v110, v111
    v_add_f32 v1, v96, v97
    v_add_f32 v2, v98, v99
    v_add_f32 v3, v100, v101
    v_add_f32 v4, v102, v103
    ds_read_b64_tr_b16 v[234:235], v38 offset:14336
    v_add_f32 v1, v1, v104
    v_add_f32 v2, v2, v105
    v_add_f32 v3, v3, v106
    v_mfma_f32_32x32x16_bf16 v[80:95], v[204:207], v[76:79], v[80:95]
    v_add_f32 v4, v4, v107
    ds_read_b64_tr_b16 v[236:237], v39 offset:12288
    v_add_f32 v1, v1, v108
    v_add_f32 v2, v2, v109
    v_add_f32 v3, v3, v110
    v_add_f32 v4, v4, v111
    ds_read_b64_tr_b16 v[238:239], v39 offset:14336
    v_add_f32 v1, v1, v2
    v_add_f32 v3, v3, v4
    v_add_f32 v1, v1, v3
    v_add_f32 v12, v12, v1
    s_waitcnt lgkmcnt(0)
    ds_read_b128 v[176:179], v28 offset:24576
    ds_read_b128 v[180:183], v29 offset:24576
    v_mfma_f32_32x32x16_bf16 v[112:127], v[208:211], v[40:43], v[112:127]
    ds_read_b128 v[184:187], v30 offset:24576
    ds_read_b128 v[188:191], v31 offset:24576
    v_mfma_f32_32x32x16_bf16 v[128:143], v[212:215], v[40:43], v[128:143]
    ds_read_b128 v[192:195], v32 offset:24576
    ds_read_b128 v[196:199], v33 offset:24576
    v_mfma_f32_32x32x16_bf16 v[144:159], v[216:219], v[40:43], v[144:159]
    ds_read_b128 v[200:203], v34 offset:24576
    ds_read_b128 v[204:207], v35 offset:24576
    v_mfma_f32_32x32x16_bf16 v[160:175], v[220:223], v[40:43], v[160:175]
    v_mfma_f32_32x32x16_bf16 v[112:127], v[224:227], v[44:47], v[112:127]
    v_mfma_f32_32x32x16_bf16 v[128:143], v[228:231], v[44:47], v[128:143]
    v_mfma_f32_32x32x16_bf16 v[144:159], v[232:235], v[44:47], v[144:159]
    v_mfma_f32_32x32x16_bf16 v[160:175], v[236:239], v[44:47], v[160:175]
    s_waitcnt vmcnt(2) lgkmcnt(0)
    s_barrier
    v_mfma_f32_32x32x16_bf16 v[96:111], v[176:179], v[48:51], 0
    v_max3_f32 v1, v80, v81, v82
    ds_read_b64_tr_b16 v[208:209], v36 offset:16384
    v_max3_f32 v2, v83, v84, v85
    v_max3_f32 v3, v86, v87, v88
    v_max3_f32 v4, v89, v90, v91
    v_max3_f32 v1, v1, v92, v93
    ds_read_b64_tr_b16 v[210:211], v36 offset:18432
    v_max3_f32 v2, v2, v94, v95
    v_max3_f32 v1, v1, v2, v3
    v_max_f32 v1, v1, v4
    v_mfma_f32_32x32x16_bf16 v[96:111], v[180:183], v[52:55], v[96:111]
    v_mov_b32 v2, v1
    s_nop 1
    v_permlane32_swap_b32 v1, v2
    ds_read_b64_tr_b16 v[212:213], v37 offset:16384
    v_max_f32 v1, v1, v2
    v_mul_f32 v1, s36, v1
    v_sub_f32 v3, v1, v10
    v_cmp_lt_f32 vcc, s37, v3
    s_cbranch_vccz L_gqa_attn_kernel_skip31
    v_max_f32 v4, v10, v1
    v_sub_f32 v3, v10, v4
    v_exp_f32 v3, v3
    v_mov_b32 v10, v4
    s_nop 7
    v_mul_f32 v12, v12, v3
    v_mul_f32 v112, v112, v3
    v_mul_f32 v113, v113, v3
    v_mul_f32 v114, v114, v3
    v_mul_f32 v115, v115, v3
    v_mul_f32 v116, v116, v3
    v_mul_f32 v117, v117, v3
    v_mul_f32 v118, v118, v3
    v_mul_f32 v119, v119, v3
    v_mul_f32 v120, v120, v3
    v_mul_f32 v121, v121, v3
    v_mul_f32 v122, v122, v3
    v_mul_f32 v123, v123, v3
    v_mul_f32 v124, v124, v3
    v_mul_f32 v125, v125, v3
    v_mul_f32 v126, v126, v3
    v_mul_f32 v127, v127, v3
    v_mul_f32 v128, v128, v3
    v_mul_f32 v129, v129, v3
    v_mul_f32 v130, v130, v3
    v_mul_f32 v131, v131, v3
    v_mul_f32 v132, v132, v3
    v_mul_f32 v133, v133, v3
    v_mul_f32 v134, v134, v3
    v_mul_f32 v135, v135, v3
    v_mul_f32 v136, v136, v3
    v_mul_f32 v137, v137, v3
    v_mul_f32 v138, v138, v3
    v_mul_f32 v139, v139, v3
    v_mul_f32 v140, v140, v3
    v_mul_f32 v141, v141, v3
    v_mul_f32 v142, v142, v3
    v_mul_f32 v143, v143, v3
    v_mul_f32 v144, v144, v3
    v_mul_f32 v145, v145, v3
    v_mul_f32 v146, v146, v3
    v_mul_f32 v147, v147, v3
    v_mul_f32 v148, v148, v3
    v_mul_f32 v149, v149, v3
    v_mul_f32 v150, v150, v3
    v_mul_f32 v151, v151, v3
    v_mul_f32 v152, v152, v3
    v_mul_f32 v153, v153, v3
    v_mul_f32 v154, v154, v3
    v_mul_f32 v155, v155, v3
    v_mul_f32 v156, v156, v3
    v_mul_f32 v157, v157, v3
    v_mul_f32 v158, v158, v3
    v_mul_f32 v159, v159, v3
    v_mul_f32 v160, v160, v3
    v_mul_f32 v161, v161, v3
    v_mul_f32 v162, v162, v3
    v_mul_f32 v163, v163, v3
    v_mul_f32 v164, v164, v3
    v_mul_f32 v165, v165, v3
    v_mul_f32 v166, v166, v3
    v_mul_f32 v167, v167, v3
    v_mul_f32 v168, v168, v3
    v_mul_f32 v169, v169, v3
    v_mul_f32 v170, v170, v3
    v_mul_f32 v171, v171, v3
    v_mul_f32 v172, v172, v3
    v_mul_f32 v173, v173, v3
    v_mul_f32 v174, v174, v3
    v_mul_f32 v175, v175, v3
    s_nop 1
L_gqa_attn_kernel_skip31:
    ds_read_b64_tr_b16 v[214:215], v37 offset:18432
    v_fma_f32 v80, v80, s36, -v10
    v_fma_f32 v81, v81, s36, -v10
    v_fma_f32 v82, v82, s36, -v10
    v_fma_f32 v83, v83, s36, -v10
    v_mfma_f32_32x32x16_bf16 v[96:111], v[184:187], v[56:59], v[96:111]
    v_fma_f32 v84, v84, s36, -v10
    ds_read_b64_tr_b16 v[216:217], v38 offset:16384
    v_fma_f32 v85, v85, s36, -v10
    v_fma_f32 v86, v86, s36, -v10
    v_fma_f32 v87, v87, s36, -v10
    v_fma_f32 v88, v88, s36, -v10
    ds_read_b64_tr_b16 v[218:219], v38 offset:18432
    v_fma_f32 v89, v89, s36, -v10
    v_fma_f32 v90, v90, s36, -v10
    v_fma_f32 v91, v91, s36, -v10
    v_mfma_f32_32x32x16_bf16 v[96:111], v[188:191], v[60:63], v[96:111]
    v_fma_f32 v92, v92, s36, -v10
    ds_read_b64_tr_b16 v[220:221], v39 offset:16384
    v_fma_f32 v93, v93, s36, -v10
    v_fma_f32 v94, v94, s36, -v10
    v_fma_f32 v95, v95, s36, -v10
    v_exp_f32 v80, v80
    v_exp_f32 v81, v81
    ds_read_b64_tr_b16 v[222:223], v39 offset:18432
    v_exp_f32 v82, v82
    v_exp_f32 v83, v83
    v_exp_f32 v84, v84
    v_mfma_f32_32x32x16_bf16 v[96:111], v[192:195], v[64:67], v[96:111]
    v_exp_f32 v85, v85
    s_waitcnt lgkmcnt(7)
    ds_read_b64_tr_b16 v[224:225], v36 offset:20480
    v_exp_f32 v86, v86
    v_exp_f32 v87, v87
    v_exp_f32 v88, v88
    v_exp_f32 v89, v89
    ds_read_b64_tr_b16 v[226:227], v36 offset:22528
    v_exp_f32 v90, v90
    v_exp_f32 v91, v91
    v_exp_f32 v92, v92
    v_exp_f32 v93, v93
    v_mfma_f32_32x32x16_bf16 v[96:111], v[196:199], v[68:71], v[96:111]
    v_exp_f32 v94, v94
    ds_read_b64_tr_b16 v[228:229], v37 offset:20480
    v_exp_f32 v95, v95
    v_cvt_pk_bf16_f32 v40, v80, v81
    v_cvt_pk_bf16_f32 v41, v82, v83
    v_cvt_pk_bf16_f32 v42, v84, v85
    ds_read_b64_tr_b16 v[230:231], v37 offset:22528
    v_cvt_pk_bf16_f32 v43, v86, v87
    v_cvt_pk_bf16_f32 v44, v88, v89
    v_cvt_pk_bf16_f32 v45, v90, v91
    v_mfma_f32_32x32x16_bf16 v[96:111], v[200:203], v[72:75], v[96:111]
    v_cvt_pk_bf16_f32 v46, v92, v93
    ds_read_b64_tr_b16 v[232:233], v38 offset:20480
    v_cvt_pk_bf16_f32 v47, v94, v95
    v_add_f32 v1, v80, v81
    v_add_f32 v2, v82, v83
    v_add_f32 v3, v84, v85
    v_add_f32 v4, v86, v87
    ds_read_b64_tr_b16 v[234:235], v38 offset:22528
    v_add_f32 v1, v1, v88
    v_add_f32 v2, v2, v89
    v_add_f32 v3, v3, v90
    v_mfma_f32_32x32x16_bf16 v[96:111], v[204:207], v[76:79], v[96:111]
    v_add_f32 v4, v4, v91
    ds_read_b64_tr_b16 v[236:237], v39 offset:20480
    v_add_f32 v1, v1, v92
    v_add_f32 v2, v2, v93
    v_add_f32 v3, v3, v94
    v_add_f32 v4, v4, v95
    ds_read_b64_tr_b16 v[238:239], v39 offset:22528
    v_add_f32 v1, v1, v2
    v_add_f32 v3, v3, v4
    v_add_f32 v1, v1, v3
    v_add_f32 v12, v12, v1
    s_waitcnt lgkmcnt(0)
    v_mfma_f32_32x32x16_bf16 v[112:127], v[208:211], v[40:43], v[112:127]
    v_mfma_f32_32x32x16_bf16 v[128:143], v[212:215], v[40:43], v[128:143]
    v_mfma_f32_32x32x16_bf16 v[144:159], v[216:219], v[40:43], v[144:159]
    v_mfma_f32_32x32x16_bf16 v[160:175], v[220:223], v[40:43], v[160:175]
    v_mfma_f32_32x32x16_bf16 v[112:127], v[224:227], v[44:47], v[112:127]
    v_mfma_f32_32x32x16_bf16 v[128:143], v[228:231], v[44:47], v[128:143]
    v_mfma_f32_32x32x16_bf16 v[144:159], v[232:235], v[44:47], v[144:159]
    v_mfma_f32_32x32x16_bf16 v[160:175], v[236:239], v[44:47], v[160:175]
    s_waitcnt vmcnt(0) lgkmcnt(0)
    s_barrier
    v_max3_f32 v1, v96, v97, v98
    ds_read_b64_tr_b16 v[208:209], v36 offset:24576
    v_max3_f32 v2, v99, v100, v101
    v_max3_f32 v3, v102, v103, v104
    v_max3_f32 v4, v105, v106, v107
    v_max3_f32 v1, v1, v108, v109
    ds_read_b64_tr_b16 v[210:211], v36 offset:26624
    v_max3_f32 v2, v2, v110, v111
    v_max3_f32 v1, v1, v2, v3
    v_max_f32 v1, v1, v4
    v_mov_b32 v2, v1
    s_nop 1
    v_permlane32_swap_b32 v1, v2
    ds_read_b64_tr_b16 v[212:213], v37 offset:24576
    v_max_f32 v1, v1, v2
    v_mul_f32 v1, s36, v1
    v_sub_f32 v3, v1, v10
    v_cmp_lt_f32 vcc, s37, v3
    s_cbranch_vccz L_gqa_attn_kernel_skip32
    v_max_f32 v4, v10, v1
    v_sub_f32 v3, v10, v4
    v_exp_f32 v3, v3
    v_mov_b32 v10, v4
    s_nop 7
    v_mul_f32 v12, v12, v3
    v_mul_f32 v112, v112, v3
    v_mul_f32 v113, v113, v3
    v_mul_f32 v114, v114, v3
    v_mul_f32 v115, v115, v3
    v_mul_f32 v116, v116, v3
    v_mul_f32 v117, v117, v3
    v_mul_f32 v118, v118, v3
    v_mul_f32 v119, v119, v3
    v_mul_f32 v120, v120, v3
    v_mul_f32 v121, v121, v3
    v_mul_f32 v122, v122, v3
    v_mul_f32 v123, v123, v3
    v_mul_f32 v124, v124, v3
    v_mul_f32 v125, v125, v3
    v_mul_f32 v126, v126, v3
    v_mul_f32 v127, v127, v3
    v_mul_f32 v128, v128, v3
    v_mul_f32 v129, v129, v3
    v_mul_f32 v130, v130, v3
    v_mul_f32 v131, v131, v3
    v_mul_f32 v132, v132, v3
    v_mul_f32 v133, v133, v3
    v_mul_f32 v134, v134, v3
    v_mul_f32 v135, v135, v3
    v_mul_f32 v136, v136, v3
    v_mul_f32 v137, v137, v3
    v_mul_f32 v138, v138, v3
    v_mul_f32 v139, v139, v3
    v_mul_f32 v140, v140, v3
    v_mul_f32 v141, v141, v3
    v_mul_f32 v142, v142, v3
    v_mul_f32 v143, v143, v3
    v_mul_f32 v144, v144, v3
    v_mul_f32 v145, v145, v3
    v_mul_f32 v146, v146, v3
    v_mul_f32 v147, v147, v3
    v_mul_f32 v148, v148, v3
    v_mul_f32 v149, v149, v3
    v_mul_f32 v150, v150, v3
    v_mul_f32 v151, v151, v3
    v_mul_f32 v152, v152, v3
    v_mul_f32 v153, v153, v3
    v_mul_f32 v154, v154, v3
    v_mul_f32 v155, v155, v3
    v_mul_f32 v156, v156, v3
    v_mul_f32 v157, v157, v3
    v_mul_f32 v158, v158, v3
    v_mul_f32 v159, v159, v3
    v_mul_f32 v160, v160, v3
    v_mul_f32 v161, v161, v3
    v_mul_f32 v162, v162, v3
    v_mul_f32 v163, v163, v3
    v_mul_f32 v164, v164, v3
    v_mul_f32 v165, v165, v3
    v_mul_f32 v166, v166, v3
    v_mul_f32 v167, v167, v3
    v_mul_f32 v168, v168, v3
    v_mul_f32 v169, v169, v3
    v_mul_f32 v170, v170, v3
    v_mul_f32 v171, v171, v3
    v_mul_f32 v172, v172, v3
    v_mul_f32 v173, v173, v3
    v_mul_f32 v174, v174, v3
    v_mul_f32 v175, v175, v3
    s_nop 1
L_gqa_attn_kernel_skip32:
    ds_read_b64_tr_b16 v[214:215], v37 offset:26624
    v_fma_f32 v96, v96, s36, -v10
    v_fma_f32 v97, v97, s36, -v10
    v_fma_f32 v98, v98, s36, -v10
    v_fma_f32 v99, v99, s36, -v10
    v_fma_f32 v100, v100, s36, -v10
    ds_read_b64_tr_b16 v[216:217], v38 offset:24576
    v_fma_f32 v101, v101, s36, -v10
    v_fma_f32 v102, v102, s36, -v10
    v_fma_f32 v103, v103, s36, -v10
    v_fma_f32 v104, v104, s36, -v10
    ds_read_b64_tr_b16 v[218:219], v38 offset:26624
    v_fma_f32 v105, v105, s36, -v10
    v_fma_f32 v106, v106, s36, -v10
    v_fma_f32 v107, v107, s36, -v10
    v_fma_f32 v108, v108, s36, -v10
    ds_read_b64_tr_b16 v[220:221], v39 offset:24576
    v_fma_f32 v109, v109, s36, -v10
    v_fma_f32 v110, v110, s36, -v10
    v_fma_f32 v111, v111, s36, -v10
    v_exp_f32 v96, v96
    v_exp_f32 v97, v97
    ds_read_b64_tr_b16 v[222:223], v39 offset:26624
    v_exp_f32 v98, v98
    v_exp_f32 v99, v99
    v_exp_f32 v100, v100
    v_exp_f32 v101, v101
    s_waitcnt lgkmcnt(7)
    ds_read_b64_tr_b16 v[224:225], v36 offset:28672
    v_exp_f32 v102, v102
    v_exp_f32 v103, v103
    v_exp_f32 v104, v104
    v_exp_f32 v105, v105
    ds_read_b64_tr_b16 v[226:227], v36 offset:30720
    v_exp_f32 v106, v106
    v_exp_f32 v107, v107
    v_exp_f32 v108, v108
    v_exp_f32 v109, v109
    v_exp_f32 v110, v110
    ds_read_b64_tr_b16 v[228:229], v37 offset:28672
    v_exp_f32 v111, v111
    v_cvt_pk_bf16_f32 v40, v96, v97
    v_cvt_pk_bf16_f32 v41, v98, v99
    v_cvt_pk_bf16_f32 v42, v100, v101
    ds_read_b64_tr_b16 v[230:231], v37 offset:30720
    v_cvt_pk_bf16_f32 v43, v102, v103
    v_cvt_pk_bf16_f32 v44, v104, v105
    v_cvt_pk_bf16_f32 v45, v106, v107
    v_cvt_pk_bf16_f32 v46, v108, v109
    ds_read_b64_tr_b16 v[232:233], v38 offset:28672
    v_cvt_pk_bf16_f32 v47, v110, v111
    v_add_f32 v1, v96, v97
    v_add_f32 v2, v98, v99
    v_add_f32 v3, v100, v101
    v_add_f32 v4, v102, v103
    ds_read_b64_tr_b16 v[234:235], v38 offset:30720
    v_add_f32 v1, v1, v104
    v_add_f32 v2, v2, v105
    v_add_f32 v3, v3, v106
    v_add_f32 v4, v4, v107
    ds_read_b64_tr_b16 v[236:237], v39 offset:28672
    v_add_f32 v1, v1, v108
    v_add_f32 v2, v2, v109
    v_add_f32 v3, v3, v110
    v_add_f32 v4, v4, v111
    ds_read_b64_tr_b16 v[238:239], v39 offset:30720
    v_add_f32 v1, v1, v2
    v_add_f32 v3, v3, v4
    v_add_f32 v1, v1, v3
    v_add_f32 v12, v12, v1
    s_waitcnt lgkmcnt(0)
    v_mfma_f32_32x32x16_bf16 v[112:127], v[208:211], v[40:43], v[112:127]
    v_mfma_f32_32x32x16_bf16 v[128:143], v[212:215], v[40:43], v[128:143]
    v_mfma_f32_32x32x16_bf16 v[144:159], v[216:219], v[40:43], v[144:159]
    v_mfma_f32_32x32x16_bf16 v[160:175], v[220:223], v[40:43], v[160:175]
    v_mfma_f32_32x32x16_bf16 v[112:127], v[224:227], v[44:47], v[112:127]
    v_mfma_f32_32x32x16_bf16 v[128:143], v[228:231], v[44:47], v[128:143]
    v_mfma_f32_32x32x16_bf16 v[144:159], v[232:235], v[44:47], v[144:159]
    v_mfma_f32_32x32x16_bf16 v[160:175], v[236:239], v[44:47], v[160:175]
    s_nop 15
    v_mov_b32 v2, v12
    s_nop 1
    v_permlane32_swap_b32 v12, v2
    v_add_f32 v12, v12, v2
    s_waitcnt vmcnt(0) lgkmcnt(0)
    s_barrier
    s_lshl_b32 s39, s2, 3
    s_add_u32 s39, s39, s28
    s_lshl_b32 s39, s39, 12
    v_lshlrev_b32 v3, 4, v0
    v_add_u32 v3, s39, v3
    buffer_load_dwordx4 v[80:83], v3, s[44:47], 0 offen offset:0
    buffer_load_dwordx4 v[84:87], v3, s[44:47], 0 offen offset:1024
    buffer_load_dwordx4 v[88:91], v3, s[44:47], 0 offen offset:2048
    buffer_load_dwordx4 v[92:95], v3, s[44:47], 0 offen offset:3072
    s_lshl_b32 s39, s30, 14
    v_lshlrev_b32 v1, 4, v0
    v_add_u32 v1, s39, v1
    s_lshl_b32 s39, s30, 9
    s_add_u32 s39, s39, 65536
    v_lshlrev_b32 v2, 3, v0
    v_add_u32 v2, s39, v2
    s_cmp_eq_u32 s29, 0
    s_cbranch_scc1 L_gqa_attn_kernel_xwait
    ds_write_b128 v1, v[112:115] offset:0
    ds_write_b128 v1, v[116:119] offset:1024
    ds_write_b128 v1, v[120:123] offset:2048
    ds_write_b128 v1, v[124:127] offset:3072
    ds_write_b128 v1, v[128:131] offset:4096
    ds_write_b128 v1, v[132:135] offset:5120
    ds_write_b128 v1, v[136:139] offset:6144
    ds_write_b128 v1, v[140:143] offset:7168
    ds_write_b128 v1, v[144:147] offset:8192
    ds_write_b128 v1, v[148:151] offset:9216
    ds_write_b128 v1, v[152:155] offset:10240
    ds_write_b128 v1, v[156:159] offset:11264
    ds_write_b128 v1, v[160:163] offset:12288
    ds_write_b128 v1, v[164:167] offset:13312
    ds_write_b128 v1, v[168:171] offset:14336
    ds_write_b128 v1, v[172:175] offset:15360
    v_mov_b32 v14, v10
    v_mov_b32 v15, v12
    ds_write_b64 v2, v[14:15]
    s_waitcnt lgkmcnt(0)
L_gqa_attn_kernel_xwait:
    s_barrier
    s_cmp_lg_u32 s29, 0
    s_cbranch_scc1 L_gqa_attn_kernel_end
    ds_read_b64 v[14:15], v2
    ds_read_b128 v[176:179], v1 offset:0
    ds_read_b128 v[180:183], v1 offset:1024
    ds_read_b128 v[184:187], v1 offset:2048
    ds_read_b128 v[188:191], v1 offset:3072
    ds_read_b128 v[192:195], v1 offset:4096
    ds_read_b128 v[196:199], v1 offset:5120
    ds_read_b128 v[200:203], v1 offset:6144
    ds_read_b128 v[204:207], v1 offset:7168
    s_waitcnt lgkmcnt(8)
    v_max_f32 v5, v10, v14
    v_sub_f32 v6, v10, v5
    v_sub_f32 v7, v14, v5
    v_exp_f32 v6, v6
    v_exp_f32 v7, v7
    s_nop 1
    v_mul_f32 v5, v6, v12
    v_fmac_f32 v5, v7, v15
    v_rcp_f32 v5, v5
    s_nop 1
    v_mul_f32 v6, v6, v5
    v_mul_f32 v7, v7, v5
    s_waitcnt lgkmcnt(0)
    ds_read_b128 v[208:211], v1 offset:8192
    ds_read_b128 v[212:215], v1 offset:9216
    ds_read_b128 v[216:219], v1 offset:10240
    ds_read_b128 v[220:223], v1 offset:11264
    ds_read_b128 v[224:227], v1 offset:12288
    ds_read_b128 v[228:231], v1 offset:13312
    ds_read_b128 v[232:235], v1 offset:14336
    ds_read_b128 v[236:239], v1 offset:15360
    v_mul_f32 v112, v112, v6
    v_fmac_f32 v112, v176, v7
    v_mul_f32 v113, v113, v6
    v_fmac_f32 v113, v177, v7
    v_mul_f32 v114, v114, v6
    v_fmac_f32 v114, v178, v7
    v_mul_f32 v115, v115, v6
    v_fmac_f32 v115, v179, v7
    v_mul_f32 v116, v116, v6
    v_fmac_f32 v116, v180, v7
    v_mul_f32 v117, v117, v6
    v_fmac_f32 v117, v181, v7
    v_mul_f32 v118, v118, v6
    v_fmac_f32 v118, v182, v7
    v_mul_f32 v119, v119, v6
    v_fmac_f32 v119, v183, v7
    v_mul_f32 v120, v120, v6
    v_fmac_f32 v120, v184, v7
    v_mul_f32 v121, v121, v6
    v_fmac_f32 v121, v185, v7
    v_mul_f32 v122, v122, v6
    v_fmac_f32 v122, v186, v7
    v_mul_f32 v123, v123, v6
    v_fmac_f32 v123, v187, v7
    v_mul_f32 v124, v124, v6
    v_fmac_f32 v124, v188, v7
    v_mul_f32 v125, v125, v6
    v_fmac_f32 v125, v189, v7
    v_mul_f32 v126, v126, v6
    v_fmac_f32 v126, v190, v7
    v_mul_f32 v127, v127, v6
    v_fmac_f32 v127, v191, v7
    v_mul_f32 v128, v128, v6
    v_fmac_f32 v128, v192, v7
    v_mul_f32 v129, v129, v6
    v_fmac_f32 v129, v193, v7
    v_mul_f32 v130, v130, v6
    v_fmac_f32 v130, v194, v7
    v_mul_f32 v131, v131, v6
    v_fmac_f32 v131, v195, v7
    v_mul_f32 v132, v132, v6
    v_fmac_f32 v132, v196, v7
    v_mul_f32 v133, v133, v6
    v_fmac_f32 v133, v197, v7
    v_mul_f32 v134, v134, v6
    v_fmac_f32 v134, v198, v7
    v_mul_f32 v135, v135, v6
    v_fmac_f32 v135, v199, v7
    v_mul_f32 v136, v136, v6
    v_fmac_f32 v136, v200, v7
    v_mul_f32 v137, v137, v6
    v_fmac_f32 v137, v201, v7
    v_mul_f32 v138, v138, v6
    v_fmac_f32 v138, v202, v7
    v_mul_f32 v139, v139, v6
    v_fmac_f32 v139, v203, v7
    v_mul_f32 v140, v140, v6
    v_fmac_f32 v140, v204, v7
    v_mul_f32 v141, v141, v6
    v_fmac_f32 v141, v205, v7
    v_mul_f32 v142, v142, v6
    v_fmac_f32 v142, v206, v7
    v_mul_f32 v143, v143, v6
    v_fmac_f32 v143, v207, v7
    s_waitcnt lgkmcnt(0)
    v_mul_f32 v144, v144, v6
    v_fmac_f32 v144, v208, v7
    v_mul_f32 v145, v145, v6
    v_fmac_f32 v145, v209, v7
    v_mul_f32 v146, v146, v6
    v_fmac_f32 v146, v210, v7
    v_mul_f32 v147, v147, v6
    v_fmac_f32 v147, v211, v7
    v_mul_f32 v148, v148, v6
    v_fmac_f32 v148, v212, v7
    v_mul_f32 v149, v149, v6
    v_fmac_f32 v149, v213, v7
    v_mul_f32 v150, v150, v6
    v_fmac_f32 v150, v214, v7
    v_mul_f32 v151, v151, v6
    v_fmac_f32 v151, v215, v7
    v_mul_f32 v152, v152, v6
    v_fmac_f32 v152, v216, v7
    v_mul_f32 v153, v153, v6
    v_fmac_f32 v153, v217, v7
    v_mul_f32 v154, v154, v6
    v_fmac_f32 v154, v218, v7
    v_mul_f32 v155, v155, v6
    v_fmac_f32 v155, v219, v7
    v_mul_f32 v156, v156, v6
    v_fmac_f32 v156, v220, v7
    v_mul_f32 v157, v157, v6
    v_fmac_f32 v157, v221, v7
    v_mul_f32 v158, v158, v6
    v_fmac_f32 v158, v222, v7
    v_mul_f32 v159, v159, v6
    v_fmac_f32 v159, v223, v7
    v_mul_f32 v160, v160, v6
    v_fmac_f32 v160, v224, v7
    v_mul_f32 v161, v161, v6
    v_fmac_f32 v161, v225, v7
    v_mul_f32 v162, v162, v6
    v_fmac_f32 v162, v226, v7
    v_mul_f32 v163, v163, v6
    v_fmac_f32 v163, v227, v7
    v_mul_f32 v164, v164, v6
    v_fmac_f32 v164, v228, v7
    v_mul_f32 v165, v165, v6
    v_fmac_f32 v165, v229, v7
    v_mul_f32 v166, v166, v6
    v_fmac_f32 v166, v230, v7
    v_mul_f32 v167, v167, v6
    v_fmac_f32 v167, v231, v7
    v_mul_f32 v168, v168, v6
    v_fmac_f32 v168, v232, v7
    v_mul_f32 v169, v169, v6
    v_fmac_f32 v169, v233, v7
    v_mul_f32 v170, v170, v6
    v_fmac_f32 v170, v234, v7
    v_mul_f32 v171, v171, v6
    v_fmac_f32 v171, v235, v7
    v_mul_f32 v172, v172, v6
    v_fmac_f32 v172, v236, v7
    v_mul_f32 v173, v173, v6
    v_fmac_f32 v173, v237, v7
    v_mul_f32 v174, v174, v6
    v_fmac_f32 v174, v238, v7
    v_mul_f32 v175, v175, v6
    v_fmac_f32 v175, v239, v7
    v_cvt_pk_bf16_f32 v176, v112, v113
    v_cvt_pk_bf16_f32 v177, v114, v115
    v_cvt_pk_bf16_f32 v178, v116, v117
    v_cvt_pk_bf16_f32 v179, v118, v119
    s_nop 1
    v_permlane32_swap_b32 v176, v178
    v_permlane32_swap_b32 v177, v179
    s_nop 1
    buffer_store_dwordx4 v[176:179], v8, s[24:27], 0 offen offset:0
    v_cvt_pk_bf16_f32 v180, v120, v121
    v_cvt_pk_bf16_f32 v181, v122, v123
    v_cvt_pk_bf16_f32 v182, v124, v125
    v_cvt_pk_bf16_f32 v183, v126, v127
    s_nop 1
    v_permlane32_swap_b32 v180, v182
    v_permlane32_swap_b32 v181, v183
    s_nop 1
    buffer_store_dwordx4 v[180:183], v8, s[24:27], 0 offen offset:32
    v_cvt_pk_bf16_f32 v184, v128, v129
    v_cvt_pk_bf16_f32 v185, v130, v131
    v_cvt_pk_bf16_f32 v186, v132, v133
    v_cvt_pk_bf16_f32 v187, v134, v135
    s_nop 1
    v_permlane32_swap_b32 v184, v186
    v_permlane32_swap_b32 v185, v187
    s_nop 1
    buffer_store_dwordx4 v[184:187], v8, s[24:27], 0 offen offset:64
    v_cvt_pk_bf16_f32 v188, v136, v137
    v_cvt_pk_bf16_f32 v189, v138, v139
    v_cvt_pk_bf16_f32 v190, v140, v141
    v_cvt_pk_bf16_f32 v191, v142, v143
    s_nop 1
    v_permlane32_swap_b32 v188, v190
    v_permlane32_swap_b32 v189, v191
    s_nop 1
    buffer_store_dwordx4 v[188:191], v8, s[24:27], 0 offen offset:96
    v_cvt_pk_bf16_f32 v192, v144, v145
    v_cvt_pk_bf16_f32 v193, v146, v147
    v_cvt_pk_bf16_f32 v194, v148, v149
    v_cvt_pk_bf16_f32 v195, v150, v151
    s_nop 1
    v_permlane32_swap_b32 v192, v194
    v_permlane32_swap_b32 v193, v195
    s_nop 1
    buffer_store_dwordx4 v[192:195], v8, s[24:27], 0 offen offset:128
    v_cvt_pk_bf16_f32 v196, v152, v153
    v_cvt_pk_bf16_f32 v197, v154, v155
    v_cvt_pk_bf16_f32 v198, v156, v157
    v_cvt_pk_bf16_f32 v199, v158, v159
    s_nop 1
    v_permlane32_swap_b32 v196, v198
    v_permlane32_swap_b32 v197, v199
    s_nop 1
    buffer_store_dwordx4 v[196:199], v8, s[24:27], 0 offen offset:160
    v_cvt_pk_bf16_f32 v200, v160, v161
    v_cvt_pk_bf16_f32 v201, v162, v163
    v_cvt_pk_bf16_f32 v202, v164, v165
    v_cvt_pk_bf16_f32 v203, v166, v167
    s_nop 1
    v_permlane32_swap_b32 v200, v202
    v_permlane32_swap_b32 v201, v203
    s_nop 1
    buffer_store_dwordx4 v[200:203], v8, s[24:27], 0 offen offset:192
    v_cvt_pk_bf16_f32 v204, v168, v169
    v_cvt_pk_bf16_f32 v205, v170, v171
    v_cvt_pk_bf16_f32 v206, v172, v173
    v_cvt_pk_bf16_f32 v207, v174, v175
    s_nop 1
    v_permlane32_swap_b32 v204, v206
    v_permlane32_swap_b32 v205, v207
    s_nop 1
    buffer_store_dwordx4 v[204:207], v8, s[24:27], 0 offen offset:224
L_gqa_attn_kernel_end:
    s_endpgm

.globl gqa_oproj_kernel
.p2align 8
.type gqa_oproj_kernel,@function
gqa_oproj_kernel:
    s_cmp_ge_u32 s2, 256
    s_cbranch_scc1 L_gqa_oproj_kernel_end
    s_load_dwordx2 s[4:5], s[0:1], 56
    s_load_dwordx2 s[6:7], s[0:1], 32
    s_load_dwordx2 s[8:9], s[0:1], 40
    v_lshrrev_b32 v1, 6, v0
    v_and_b32 v0, 63, v0
    s_nop 1
    v_readfirstlane_b32 s24, v1
    s_nop 3
    s_lshl_b32 s25, s24, 10
    s_and_b32 s31, s2, 7
    s_lshr_b32 s31, s31, 1
    s_lshl_b32 s31, s31, 2
    s_lshr_b32 s26, s2, 3
    s_and_b32 s26, s26, 3
    s_add_u32 s26, s26, s31
    s_and_b32 s31, s2, 1
    s_lshl_b32 s31, s31, 3
    s_lshr_b32 s27, s2, 5
    s_add_u32 s27, s27, s31
    s_and_b32 s35, s24, 1
    s_lshr_b32 s36, s24, 1
    s_and_b32 s36, s36, 1
    s_lshr_b32 s34, s24, 2
    s_waitcnt lgkmcnt(0)
    s_add_u32 s12, s4, 8388608
    s_addc_u32 s13, s5, 0
    s_mov_b32 s14, 8388608
    s_mov_b32 s15, 0x00020000
    s_mov_b32 s16, s6
    s_mov_b32 s17, s7
    s_mov_b32 s18, 8388608
    s_mov_b32 s19, 0x00020000
    s_mov_b32 s20, s8
    s_mov_b32 s21, s9
    s_mov_b32 s22, 2097152
    s_mov_b32 s23, 0x00020000
    v_lshrrev_b32 v1, 3, v0
    v_and_b32 v2, 7, v0
    v_lshrrev_b32 v3, 4, v0
    s_lshl_b32 s31, s24, 2
    v_add_u32 v3, s31, v3
    v_and_b32 v3, 7, v3
    v_xor_b32 v2, v2, v3
    s_lshl_b32 s31, s24, 3
    s_mul_i32 s32, s26, 64
    s_add_u32 s31, s31, s32
    v_add_u32 v1, s31, v1
    v_lshlrev_b32 v1, 13, v1
    v_lshl_add_u32 v7, v2, 4, v1
    v_lshrrev_b32 v1, 3, v0
    v_and_b32 v2, 7, v0
    v_lshrrev_b32 v3, 4, v0
    v_and_b32 v3, 1, v3
    v_lshlrev_b32 v3, 2, v3
    v_xor_b32 v2, v2, v3
    s_lshl_b32 s31, s24, 3
    v_add_u32 v1, s31, v1
    v_lshlrev_b32 v1, 11, v1
    v_lshl_add_u32 v1, v2, 4, v1
    s_mul_i32 s31, s27, 128
    v_add_u32 v8, s31, v1
    v_and_b32 v1, 31, v0
    v_lshrrev_b32 v2, 1, v1
    v_and_b32 v2, 7, v2
    v_lshrrev_b32 v3, 5, v0
    v_xor_b32 v2, v2, v3
    s_mul_i32 s31, s35, 32
    v_add_u32 v1, s31, v1
    v_lshlrev_b32 v1, 7, v1
    v_lshl_add_u32 v1, v2, 4, v1
    s_add_u32 s31, s34, 0
    s_lshl_b32 s31, s31, 5
    v_xor_b32 v9, s31, v1
    s_add_u32 s31, s34, 2
    s_lshl_b32 s31, s31, 5
    v_xor_b32 v10, s31, v1
    v_and_b32 v1, 15, v0
    v_lshrrev_b32 v2, 2, v1
    v_and_b32 v1, 3, v1
    v_lshrrev_b32 v3, 5, v0
    v_lshl_add_u32 v3, v3, 3, v2
    v_lshlrev_b32 v3, 7, v3
    v_lshl_add_u32 v3, v1, 3, v3
    v_lshrrev_b32 v1, 4, v0
    v_and_b32 v1, 1, v1
    v_lshl_add_u32 v3, v1, 5, v3
    v_lshrrev_b32 v2, 1, v2
    v_xor_b32 v2, s36, v2
    v_lshl_add_u32 v3, v2, 6, v3
    s_lshl_b32 s31, s34, 11
    s_add_u32 s31, s31, 32768
    v_add_u32 v11, s31, v3
    v_and_b32 v1, 31, v0
    s_mul_i32 s31, s26, 64
    s_mul_i32 s32, s35, 32
    s_add_u32 s31, s31, s32
    v_add_u32 v1, s31, v1
    v_lshlrev_b32 v1, 11, v1
    v_lshrrev_b32 v2, 5, v0
    v_lshl_add_u32 v1, v2, 4, v1
    s_mul_i32 s31, s27, 128
    s_lshl_b32 s32, s36, 6
    s_add_u32 s31, s31, s32
    v_add_u32 v12, s31, v1
    v_mov_b32 v16, 0
    v_mov_b32 v17, 0
    v_mov_b32 v18, 0
    v_mov_b32 v19, 0
    v_mov_b32 v20, 0
    v_mov_b32 v21, 0
    v_mov_b32 v22, 0
    v_mov_b32 v23, 0
    v_mov_b32 v24, 0
    v_mov_b32 v25, 0
    v_mov_b32 v26, 0
    v_mov_b32 v27, 0
    v_mov_b32 v28, 0
    v_mov_b32 v29, 0
    v_mov_b32 v30, 0
    v_mov_b32 v31, 0
    s_mov_b32 s28, 0
    s_mov_b32 s29, 0
    s_add_u32 m0, s25, 0
    s_nop 0
    buffer_load_dwordx4 v7, s[12:15], s28 offen lds
    s_add_u32 m0, s25, 32768
    s_nop 0
    buffer_load_dwordx4 v8, s[16:19], s29 offen lds
    s_add_u32 s28, s28, 128
    s_add_u32 s29, s29, 131072
    s_add_u32 m0, s25, 8192
    s_nop 0
    buffer_load_dwordx4 v7, s[12:15], s28 offen lds
    s_add_u32 m0, s25, 40960
    s_nop 0
    buffer_load_dwordx4 v8, s[16:19], s29 offen lds
    s_add_u32 s28, s28, 128
    s_add_u32 s29, s29, 131072
    s_add_u32 m0, s25, 16384
    s_nop 0
    buffer_load_dwordx4 v7, s[12:15], s28 offen lds
    s_add_u32 m0, s25, 49152
    s_nop 0
    buffer_load_dwordx4 v8, s[16:19], s29 offen lds
    s_add_u32 s28, s28, 128
    s_add_u32 s29, s29, 131072
    s_mov_b32 s30, 15
L_gqa_oproj_kernel_loop:
    s_waitcnt vmcnt(4) lgkmcnt(0)
    s_barrier
    s_add_u32 m0, s25, 24576
    s_nop 0
    buffer_load_dwordx4 v7, s[12:15], s28 offen lds
    s_add_u32 m0, s25, 57344
    s_nop 0
    buffer_load_dwordx4 v8, s[16:19], s29 offen lds
    s_add_u32 s28, s28, 128
    s_add_u32 s29, s29, 131072
    ds_read_b64_tr_b16 v[40:41], v11 offset:0
    ds_read_b64_tr_b16 v[42:43], v11 offset:512
    ds_read_b128 v[32:35], v9 offset:0
    ds_read_b64_tr_b16 v[44:45], v11 offset:4096
    ds_read_b64_tr_b16 v[46:47], v11 offset:4608
    ds_read_b128 v[36:39], v10 offset:0
    s_waitcnt lgkmcnt(3)
    v_mfma_f32_32x32x16_bf16 v[16:31], v[40:43], v[32:35], v[16:31]
    s_waitcnt lgkmcnt(0)
    v_mfma_f32_32x32x16_bf16 v[16:31], v[44:47], v[36:39], v[16:31]
    s_waitcnt vmcnt(4) lgkmcnt(0)
    s_barrier
    s_add_u32 m0, s25, 0
    s_nop 0
    buffer_load_dwordx4 v7, s[12:15], s28 offen lds
    s_add_u32 m0, s25, 32768
    s_nop 0
    buffer_load_dwordx4 v8, s[16:19], s29 offen lds
    s_add_u32 s28, s28, 128
    s_add_u32 s29, s29, 131072
    ds_read_b64_tr_b16 v[40:41], v11 offset:8192
    ds_read_b64_tr_b16 v[42:43], v11 offset:8704
    ds_read_b128 v[32:35], v9 offset:8192
    ds_read_b64_tr_b16 v[44:45], v11 offset:12288
    ds_read_b64_tr_b16 v[46:47], v11 offset:12800
    ds_read_b128 v[36:39], v10 offset:8192
    s_waitcnt lgkmcnt(3)
    v_mfma_f32_32x32x16_bf16 v[16:31], v[40:43], v[32:35], v[16:31]
    s_waitcnt lgkmcnt(0)
    v_mfma_f32_32x32x16_bf16 v[16:31], v[44:47], v[36:39], v[16:31]
    s_waitcnt vmcnt(4) lgkmcnt(0)
    s_barrier
    s_add_u32 m0, s25, 8192
    s_nop 0
    buffer_load_dwordx4 v7, s[12:15], s28 offen lds
    s_add_u32 m0, s25, 40960
    s_nop 0
    buffer_load_dwordx4 v8, s[16:19], s29 offen lds
    s_add_u32 s28, s28, 128
    s_add_u32 s29, s29, 131072
    ds_read_b64_tr_b16 v[40:41], v11 offset:16384
    ds_read_b64_tr_b16 v[42:43], v11 offset:16896
    ds_read_b128 v[32:35], v9 offset:16384
    ds_read_b64_tr_b16 v[44:45], v11 offset:20480
    ds_read_b64_tr_b16 v[46:47], v11 offset:20992
    ds_read_b128 v[36:39], v10 offset:16384
    s_waitcnt lgkmcnt(3)
    v_mfma_f32_32x32x16_bf16 v[16:31], v[40:43], v[32:35], v[16:31]
    s_waitcnt lgkmcnt(0)
    v_mfma_f32_32x32x16_bf16 v[16:31], v[44:47], v[36:39], v[16:31]
    s_waitcnt vmcnt(4) lgkmcnt(0)
    s_barrier
    s_add_u32 m0, s25, 16384
    s_nop 0
    buffer_load_dwordx4 v7, s[12:15], s28 offen lds
    s_add_u32 m0, s25, 49152
    s_nop 0
    buffer_load_dwordx4 v8, s[16:19], s29 offen lds
    s_add_u32 s28, s28, 128
    s_add_u32 s29, s29, 131072
    ds_read_b64_tr_b16 v[40:41], v11 offset:24576
    ds_read_b64_tr_b16 v[42:43], v11 offset:25088
    ds_read_b128 v[32:35], v9 offset:24576
    ds_read_b64_tr_b16 v[44:45], v11 offset:28672
    ds_read_b64_tr_b16 v[46:47], v11 offset:29184
    ds_read_b128 v[36:39], v10 offset:24576
    s_waitcnt lgkmcnt(3)
    v_mfma_f32_32x32x16_bf16 v[16:31], v[40:43], v[32:35], v[16:31]
    s_waitcnt lgkmcnt(0)
    v_mfma_f32_32x32x16_bf16 v[16:31], v[44:47], v[36:39], v[16:31]
    s_sub_u32 s30, s30, 1
    s_cmp_lg_u32 s30, 0
    s_cbranch_scc1 L_gqa_oproj_kernel_loop
    s_waitcnt vmcnt(4) lgkmcnt(0)
    s_barrier
    s_add_u32 m0, s25, 24576
    s_nop 0
    buffer_load_dwordx4 v7, s[12:15], s28 offen lds
    s_add_u32 m0, s25, 57344
    s_nop 0
    buffer_load_dwordx4 v8, s[16:19], s29 offen lds
    s_add_u32 s28, s28, 128
    s_add_u32 s29, s29, 131072
    ds_read_b64_tr_b16 v[40:41], v11 offset:0
    ds_read_b64_tr_b16 v[42:43], v11 offset:512
    ds_read_b128 v[32:35], v9 offset:0
    ds_read_b64_tr_b16 v[44:45], v11 offset:4096
    ds_read_b64_tr_b16 v[46:47], v11 offset:4608
    ds_read_b128 v[36:39], v10 offset:0
    s_waitcnt lgkmcnt(3)
    v_mfma_f32_32x32x16_bf16 v[16:31], v[40:43], v[32:35], v[16:31]
    s_waitcnt lgkmcnt(0)
    v_mfma_f32_32x32x16_bf16 v[16:31], v[44:47], v[36:39], v[16:31]
    s_waitcnt vmcnt(4) lgkmcnt(0)
    s_barrier
    ds_read_b64_tr_b16 v[40:41], v11 offset:8192
    ds_read_b64_tr_b16 v[42:43], v11 offset:8704
    ds_read_b128 v[32:35], v9 offset:8192
    ds_read_b64_tr_b16 v[44:45], v11 offset:12288
    ds_read_b64_tr_b16 v[46:47], v11 offset:12800
    ds_read_b128 v[36:39], v10 offset:8192
    s_waitcnt lgkmcnt(3)
    v_mfma_f32_32x32x16_bf16 v[16:31], v[40:43], v[32:35], v[16:31]
    s_waitcnt lgkmcnt(0)
    v_mfma_f32_32x32x16_bf16 v[16:31], v[44:47], v[36:39], v[16:31]
    s_waitcnt vmcnt(2) lgkmcnt(0)
    s_barrier
    ds_read_b64_tr_b16 v[40:41], v11 offset:16384
    ds_read_b64_tr_b16 v[42:43], v11 offset:16896
    ds_read_b128 v[32:35], v9 offset:16384
    ds_read_b64_tr_b16 v[44:45], v11 offset:20480
    ds_read_b64_tr_b16 v[46:47], v11 offset:20992
    ds_read_b128 v[36:39], v10 offset:16384
    s_waitcnt lgkmcnt(3)
    v_mfma_f32_32x32x16_bf16 v[16:31], v[40:43], v[32:35], v[16:31]
    s_waitcnt lgkmcnt(0)
    v_mfma_f32_32x32x16_bf16 v[16:31], v[44:47], v[36:39], v[16:31]
    s_waitcnt vmcnt(0) lgkmcnt(0)
    s_barrier
    ds_read_b64_tr_b16 v[40:41], v11 offset:24576
    ds_read_b64_tr_b16 v[42:43], v11 offset:25088
    ds_read_b128 v[32:35], v9 offset:24576
    ds_read_b64_tr_b16 v[44:45], v11 offset:28672
    ds_read_b64_tr_b16 v[46:47], v11 offset:29184
    ds_read_b128 v[36:39], v10 offset:24576
    s_waitcnt lgkmcnt(3)
    v_mfma_f32_32x32x16_bf16 v[16:31], v[40:43], v[32:35], v[16:31]
    s_waitcnt lgkmcnt(0)
    v_mfma_f32_32x32x16_bf16 v[16:31], v[44:47], v[36:39], v[16:31]
    s_nop 15
    s_barrier
    s_and_b32 s31, s24, 3
    s_lshl_b32 s31, s31, 12
    v_lshlrev_b32 v1, 4, v0
    v_add_u32 v1, s31, v1
    s_cmp_eq_u32 s34, 0
    s_cbranch_scc1 L_gqa_oproj_kernel_red_wait
    ds_write_b128 v1, v[16:19] offset:0
    ds_write_b128 v1, v[20:23] offset:1024
    ds_write_b128 v1, v[24:27] offset:2048
    ds_write_b128 v1, v[28:31] offset:3072
    s_waitcnt lgkmcnt(0)
L_gqa_oproj_kernel_red_wait:
    s_barrier
    s_cmp_lg_u32 s34, 0
    s_cbranch_scc1 L_gqa_oproj_kernel_end
    ds_read_b128 v[32:35], v1 offset:0
    ds_read_b128 v[36:39], v1 offset:1024
    ds_read_b128 v[40:43], v1 offset:2048
    ds_read_b128 v[44:47], v1 offset:3072
    s_waitcnt lgkmcnt(0)
    v_add_f32 v16, v16, v32
    v_add_f32 v17, v17, v33
    v_add_f32 v18, v18, v34
    v_add_f32 v19, v19, v35
    v_add_f32 v20, v20, v36
    v_add_f32 v21, v21, v37
    v_add_f32 v22, v22, v38
    v_add_f32 v23, v23, v39
    v_add_f32 v24, v24, v40
    v_add_f32 v25, v25, v41
    v_add_f32 v26, v26, v42
    v_add_f32 v27, v27, v43
    v_add_f32 v28, v28, v44
    v_add_f32 v29, v29, v45
    v_add_f32 v30, v30, v46
    v_add_f32 v31, v31, v47
    v_cvt_pk_bf16_f32 v32, v16, v17
    v_cvt_pk_bf16_f32 v33, v18, v19
    v_cvt_pk_bf16_f32 v34, v20, v21
    v_cvt_pk_bf16_f32 v35, v22, v23
    s_nop 1
    v_permlane32_swap_b32 v32, v34
    v_permlane32_swap_b32 v33, v35
    s_nop 1
    buffer_store_dwordx4 v[32:35], v12, s[20:23], 0 offen offset:0
    v_cvt_pk_bf16_f32 v36, v24, v25
    v_cvt_pk_bf16_f32 v37, v26, v27
    v_cvt_pk_bf16_f32 v38, v28, v29
    v_cvt_pk_bf16_f32 v39, v30, v31
    s_nop 1
    v_permlane32_swap_b32 v36, v38
    v_permlane32_swap_b32 v37, v39
    s_nop 1
    buffer_store_dwordx4 v[36:39], v12, s[20:23], 0 offen offset:32
L_gqa_oproj_kernel_end:
    s_endpgm

.section .rodata,"a"
.p2align 6
.amdhsa_kernel gqa_qproj_kernel
  .amdhsa_next_free_vgpr 104
  .amdhsa_next_free_sgpr 40
  .amdhsa_accum_offset 104
  .amdhsa_group_segment_fixed_size 0
  .amdhsa_kernarg_size 64
  .amdhsa_user_sgpr_count 2
  .amdhsa_user_sgpr_kernarg_segment_ptr 1
  .amdhsa_system_sgpr_workgroup_id_x 1
.end_amdhsa_kernel

.p2align 6
.amdhsa_kernel gqa_attn_kernel
  .amdhsa_next_free_vgpr 240
  .amdhsa_next_free_sgpr 48
  .amdhsa_accum_offset 240
  .amdhsa_group_segment_fixed_size 0
  .amdhsa_kernarg_size 64
  .amdhsa_user_sgpr_count 2
  .amdhsa_user_sgpr_kernarg_segment_ptr 1
  .amdhsa_system_sgpr_workgroup_id_x 1
.end_amdhsa_kernel

.p2align 6
.amdhsa_kernel gqa_oproj_kernel
  .amdhsa_next_free_vgpr 48
  .amdhsa_next_free_sgpr 40
  .amdhsa_accum_offset 48
  .amdhsa_group_segment_fixed_size 0
  .amdhsa_kernarg_size 64
  .amdhsa_user_sgpr_count 2
  .amdhsa_user_sgpr_kernarg_segment_ptr 1
  .amdhsa_system_sgpr_workgroup_id_x 1
.end_amdhsa_kernel
```
